```python
import torch

def _softmax(x, axis=-1):
    return torch.softmax(x, dim=axis)
def _gelu(x):
    return torch.nn.functional.gelu(x, approximate="tanh")
def _silu(x):
    return torch.nn.functional.silu(x)
def _sigmoid(x):
    return torch.sigmoid(x)
def _layernorm(x, axis=-1, eps=1e-5):
    m = x.mean(dim=axis, keepdim=True)
    v = x.var(dim=axis, keepdim=True, unbiased=False)
    return (x - m) / torch.sqrt(v + eps)
def _scatter_add(tgt, idx, src, axis=0):
    return tgt.clone().index_add_(axis, idx, src)
def _segment_sum(src, seg, n):
    out = torch.zeros((n,) + src.shape[1:], dtype=src.dtype)
    return out.index_add_(0, seg, src)
def _pad(x, pw):
    flat = tuple(v for pair in reversed(pw) for v in pair)
    return torch.nn.functional.pad(x, flat)

kernel_name = 'concat_heads__sliding_block__sliding_block__prompt'

def setup_inputs():

    _w = (lambda a: (lambda t: t.to(torch.bfloat16) if t.is_floating_point() else t)(torch.as_tensor(a)))
    def _A_setup():
        B, S, D = 1, 2048, 448
        return {
            "x": _w((lambda *s: torch.randn(*s, dtype=torch.bfloat16) * 0.4)(B, S, D)),
            "wqkv": _w((lambda *s: torch.randn(*s, dtype=torch.bfloat16) * 0.4)(D, 3 * D)),
            "wo": _w((lambda *s: torch.randn(*s, dtype=torch.bfloat16) * 0.05)(D, D)),
        }
    _A_in = _A_setup()

    def _B_setup():
        B, S, D = 1, 2048, 448
        return {
            "x": _w((lambda *s: torch.randn(*s, dtype=torch.bfloat16) * 0.4)(B, S, D)),
            "wqkv": _w((lambda *s: torch.randn(*s, dtype=torch.bfloat16) * 0.4)(D, 3 * D)),
            "wo": _w((lambda *s: torch.randn(*s, dtype=torch.bfloat16) * 0.05)(D, D)),
        }
    _B_in = _B_setup()

    return {
        "A_x": _A_in["x"],
        "A_wqkv": _A_in["wqkv"],
        "A_wo": _A_in["wo"],
        "B_x": _B_in["x"],
        "B_wqkv": _B_in["wqkv"],
        "B_wo": _B_in["wo"],
    }

def reference(A_x, A_wqkv, A_wo, B_x, B_wqkv, B_wo):
    def _A_ref(x, wqkv, wo):
        B, S, D = x.shape
        H = 16; Dh = D // H; W = 256
        qkv = (lambda x, *d: x.permute(*d))((x @ wqkv).reshape(B, S, 3, H, Dh), 2, 0, 3, 1, 4)
        q, k, v = qkv[0], qkv[1], qkv[2]
        scores = torch.einsum("bhqd,bhkd->bhqk", q, k) * (Dh ** -0.5)
        idx = torch.arange(S)
        mask = (idx[:, None] - idx[None, :] >= 0) & (idx[:, None] - idx[None, :] < W)
        scores = torch.where(mask[None, None], scores, -1e9)
        p = _softmax(scores, axis=-1)
        o = torch.einsum("bhqk,bhkd->bhqd", p, v)
        return (lambda x, *d: x.permute(*d))(o, 0, 2, 1, 3).reshape(B, S, D) @ wo

    def _B_ref(x, wqkv, wo):
        B, S, D = x.shape
        H = 16; Dh = D // H; W = 256
        qkv = (lambda x, *d: x.permute(*d))((x @ wqkv).reshape(B, S, 3, H, Dh), 2, 0, 3, 1, 4)
        q, k, v = qkv[0], qkv[1], qkv[2]
        scores = torch.einsum("bhqd,bhkd->bhqk", q, k) * (Dh ** -0.5)
        idx = torch.arange(S)
        mask = (idx[:, None] - idx[None, :] >= 0) & (idx[:, None] - idx[None, :] < W)
        scores = torch.where(mask[None, None], scores, -1e9)
        p = _softmax(scores, axis=-1)
        o = torch.einsum("bhqk,bhkd->bhqd", p, v)
        return (lambda x, *d: x.permute(*d))(o, 0, 2, 1, 3).reshape(B, S, D) @ wo

    a = _A_ref(A_x, A_wqkv, A_wo)
    b = _B_ref(B_x, B_wqkv, B_wo)
    return torch.concatenate([a, b], axis=-1)
```

```asm
; @launch kernel=fused_kernel grid=(232,1,1) block=(512,1,1) lds=163840
; @launch kernel=fused_kernel grid=(256,1,1) block=(512,1,1) lds=65536
; @launch kernel=fused_kernel grid=(224,1,1) block=(512,1,1) lds=57344
.amdgcn_target "amdgcn-amd-amdhsa--gfx950"
.text
.globl fused_kernel
.p2align 8
.type fused_kernel,@function
fused_kernel:
    s_getreg_b32 s3, hwreg(HW_REG_LDS_ALLOC, 12, 10)
    s_cmp_lt_u32 s3, 244
    s_cbranch_scc1 PH3
    s_cmp_lt_u32 s3, 400
    s_cbranch_scc1 PH2
    s_cmp_ge_u32 s2, 224
    s_cbranch_scc1 K1_HELP
    s_load_dwordx8 s[4:11], s[0:1], 0
    s_load_dwordx4 s[12:15], s[0:1], 32
    s_load_dwordx2 s[16:17], s[0:1], 64
    s_and_b32 s36, s2, 7
    s_lshr_b32 s37, s2, 3
    s_and_b32 s20, s36, 1
    s_lshr_b32 s38, s36, 1
    s_lshl_b32 s38, s38, 2
    s_and_b32 s39, s37, 3
    s_add_u32 s21, s38, s39
    s_lshr_b32 s22, s37, 2
    s_add_u32 s39, s39, s22
    s_mul_i32 s38, s39, 86
    s_lshr_b32 s38, s38, 8
    s_mul_i32 s38, s38, 3
    s_sub_u32 s39, s39, s38
    s_lshl_b32 s74, s39, 1
    v_lshrrev_b32 v2, 6, v0
    v_and_b32 v1, 63, v0
    s_nop 0
    v_readfirstlane_b32 s23, v2
    s_cmp_lt_u32 s23, 4
    s_cbranch_scc1 K1_COMPUTE
    s_sub_u32 s76, s23, 4
    v_add_u32 v8, 0, v1
    v_mul_u32_u24 v9, 2731, v8
    v_lshrrev_b32 v9, 16, v9
    v_mul_u32_u24 v10, 24, v9
    v_sub_u32 v10, v8, v10
    v_lshrrev_b32 v11, 1, v9
    v_and_b32 v11, 1, v11
    v_lshlrev_b32 v11, 2, v11
    v_xor_b32 v10, v10, v11
    v_mul_u32_u24 v9, 2688, v9
    v_lshlrev_b32 v10, 4, v10
    v_add_u32 v2, v9, v10
    v_add_u32 v8, 64, v1
    v_mul_u32_u24 v9, 2731, v8
    v_lshrrev_b32 v9, 16, v9
    v_mul_u32_u24 v10, 24, v9
    v_sub_u32 v10, v8, v10
    v_lshrrev_b32 v11, 1, v9
    v_and_b32 v11, 1, v11
    v_lshlrev_b32 v11, 2, v11
    v_xor_b32 v10, v10, v11
    v_mul_u32_u24 v9, 2688, v9
    v_lshlrev_b32 v10, 4, v10
    v_add_u32 v3, v9, v10
    v_add_u32 v8, 128, v1
    v_mul_u32_u24 v9, 2731, v8
    v_lshrrev_b32 v9, 16, v9
    v_mul_u32_u24 v10, 24, v9
    v_sub_u32 v10, v8, v10
    v_lshrrev_b32 v11, 1, v9
    v_and_b32 v11, 1, v11
    v_lshlrev_b32 v11, 2, v11
    v_xor_b32 v10, v10, v11
    v_mul_u32_u24 v9, 2688, v9
    v_lshlrev_b32 v10, 4, v10
    v_add_u32 v4, v9, v10
    v_lshrrev_b32 v8, 3, v1
    v_and_b32 v9, 7, v1
    v_lshrrev_b32 v10, 4, v1
    v_xor_b32 v11, v9, v10
    v_mul_u32_u24 v8, 896, v8
    v_lshlrev_b32 v12, 4, v11
    v_add_u32 v5, v8, v12
    v_xor_b32 v11, 4, v11
    v_lshlrev_b32 v12, 4, v11
    v_add_u32 v6, v8, v12
    s_lshl_b32 s36, s21, 7
    s_lshl_b32 s37, s76, 5
    s_add_u32 s36, s36, s37
    s_mul_i32 s70, s36, 896
    s_mul_i32 s36, s76, 43008
    s_mul_i32 s37, s22, 384
    s_add_u32 s71, s36, s37
    s_lshl_b32 s72, s76, 12
    s_mul_i32 s73, s76, 6144
    s_waitcnt lgkmcnt(0)
    s_add_u32 s73, s73, 16384
    s_cmp_eq_u32 s20, 0
    s_cselect_b32 s24, s4, s10
    s_cselect_b32 s25, s5, s11
    s_cselect_b32 s28, s6, s12
    s_cselect_b32 s29, s7, s13
    s_and_b32 s25, s25, 0xffff
    s_and_b32 s29, s29, 0xffff
    s_mov_b32 s26, 1835008
    s_mov_b32 s27, 0x20000
    s_mov_b32 s30, 1204224
    s_mov_b32 s31, 0x20000
    s_lshl_b32 s36, s74, 7
    s_add_u32 s36, s36, s70
    s_mul_i32 s37, s74, 172032
    s_add_u32 s37, s37, s71
    s_add_u32 s74, s74, 1
    s_cmp_eq_u32 s74, 7
    s_cselect_b32 s74, 0, s74
    s_add_u32 s38, s37, 0
    s_add_u32 m0, s73, 0
    s_nop 0
    buffer_load_dwordx4 v2, s[28:31], s38 offen lds
    s_add_u32 s38, s37, 0
    s_add_u32 m0, s73, 1024
    s_nop 0
    buffer_load_dwordx4 v3, s[28:31], s38 offen lds
    s_add_u32 s38, s37, 0
    s_add_u32 m0, s73, 2048
    s_nop 0
    buffer_load_dwordx4 v4, s[28:31], s38 offen lds
    s_add_u32 s38, s37, 21504
    s_add_u32 m0, s73, 3072
    s_nop 0
    buffer_load_dwordx4 v2, s[28:31], s38 offen lds
    s_add_u32 s38, s37, 21504
    s_add_u32 m0, s73, 4096
    s_nop 0
    buffer_load_dwordx4 v3, s[28:31], s38 offen lds
    s_add_u32 s38, s37, 21504
    s_add_u32 m0, s73, 5120
    s_nop 0
    buffer_load_dwordx4 v4, s[28:31], s38 offen lds
    s_add_u32 s38, s36, 0
    s_add_u32 m0, s72, 0
    s_nop 0
    buffer_load_dwordx4 v5, s[24:27], s38 offen lds
    s_add_u32 s38, s36, 7168
    s_add_u32 m0, s72, 1024
    s_nop 0
    buffer_load_dwordx4 v6, s[24:27], s38 offen lds
    s_add_u32 s38, s36, 14336
    s_add_u32 m0, s72, 2048
    s_nop 0
    buffer_load_dwordx4 v5, s[24:27], s38 offen lds
    s_add_u32 s38, s36, 21504
    s_add_u32 m0, s72, 3072
    s_nop 0
    buffer_load_dwordx4 v6, s[24:27], s38 offen lds
    s_lshl_b32 s36, s74, 7
    s_add_u32 s36, s36, s70
    s_mul_i32 s37, s74, 172032
    s_add_u32 s37, s37, s71
    s_add_u32 s74, s74, 1
    s_cmp_eq_u32 s74, 7
    s_cselect_b32 s74, 0, s74
    s_add_u32 s38, s37, 0
    s_add_u32 m0, s73, 40960
    s_nop 0
    buffer_load_dwordx4 v2, s[28:31], s38 offen lds
    s_add_u32 s38, s37, 0
    s_add_u32 m0, s73, 41984
    s_nop 0
    buffer_load_dwordx4 v3, s[28:31], s38 offen lds
    s_add_u32 s38, s37, 0
    s_add_u32 m0, s73, 43008
    s_nop 0
    buffer_load_dwordx4 v4, s[28:31], s38 offen lds
    s_add_u32 s38, s37, 21504
    s_add_u32 m0, s73, 44032
    s_nop 0
    buffer_load_dwordx4 v2, s[28:31], s38 offen lds
    s_add_u32 s38, s37, 21504
    s_add_u32 m0, s73, 45056
    s_nop 0
    buffer_load_dwordx4 v3, s[28:31], s38 offen lds
    s_add_u32 s38, s37, 21504
    s_add_u32 m0, s73, 46080
    s_nop 0
    buffer_load_dwordx4 v4, s[28:31], s38 offen lds
    s_add_u32 s38, s36, 0
    s_add_u32 m0, s72, 40960
    s_nop 0
    buffer_load_dwordx4 v5, s[24:27], s38 offen lds
    s_add_u32 s38, s36, 7168
    s_add_u32 m0, s72, 41984
    s_nop 0
    buffer_load_dwordx4 v6, s[24:27], s38 offen lds
    s_add_u32 s38, s36, 14336
    s_add_u32 m0, s72, 43008
    s_nop 0
    buffer_load_dwordx4 v5, s[24:27], s38 offen lds
    s_add_u32 s38, s36, 21504
    s_add_u32 m0, s72, 44032
    s_nop 0
    buffer_load_dwordx4 v6, s[24:27], s38 offen lds
    s_waitcnt vmcnt(10)
    s_barrier
    s_lshl_b32 s36, s74, 7
    s_add_u32 s36, s36, s70
    s_mul_i32 s37, s74, 172032
    s_add_u32 s37, s37, s71
    s_add_u32 s74, s74, 1
    s_cmp_eq_u32 s74, 7
    s_cselect_b32 s74, 0, s74
    s_add_u32 s38, s37, 0
    s_add_u32 m0, s73, 81920
    s_nop 0
    buffer_load_dwordx4 v2, s[28:31], s38 offen lds
    s_add_u32 s38, s37, 0
    s_add_u32 m0, s73, 82944
    s_nop 0
    buffer_load_dwordx4 v3, s[28:31], s38 offen lds
    s_add_u32 s38, s37, 0
    s_add_u32 m0, s73, 83968
    s_nop 0
    buffer_load_dwordx4 v4, s[28:31], s38 offen lds
    s_add_u32 s38, s37, 21504
    s_add_u32 m0, s73, 84992
    s_nop 0
    buffer_load_dwordx4 v2, s[28:31], s38 offen lds
    s_add_u32 s38, s37, 21504
    s_add_u32 m0, s73, 86016
    s_nop 0
    buffer_load_dwordx4 v3, s[28:31], s38 offen lds
    s_add_u32 s38, s37, 21504
    s_add_u32 m0, s73, 87040
    s_nop 0
    buffer_load_dwordx4 v4, s[28:31], s38 offen lds
    s_add_u32 s38, s36, 0
    s_add_u32 m0, s72, 81920
    s_nop 0
    buffer_load_dwordx4 v5, s[24:27], s38 offen lds
    s_add_u32 s38, s36, 7168
    s_add_u32 m0, s72, 82944
    s_nop 0
    buffer_load_dwordx4 v6, s[24:27], s38 offen lds
    s_add_u32 s38, s36, 14336
    s_add_u32 m0, s72, 83968
    s_nop 0
    buffer_load_dwordx4 v5, s[24:27], s38 offen lds
    s_add_u32 s38, s36, 21504
    s_add_u32 m0, s72, 84992
    s_nop 0
    buffer_load_dwordx4 v6, s[24:27], s38 offen lds
    s_waitcnt vmcnt(10)
    s_barrier
    s_lshl_b32 s36, s74, 7
    s_add_u32 s36, s36, s70
    s_mul_i32 s37, s74, 172032
    s_add_u32 s37, s37, s71
    s_add_u32 s74, s74, 1
    s_cmp_eq_u32 s74, 7
    s_cselect_b32 s74, 0, s74
    s_add_u32 s38, s37, 0
    s_add_u32 m0, s73, 122880
    s_nop 0
    buffer_load_dwordx4 v2, s[28:31], s38 offen lds
    s_add_u32 s38, s37, 0
    s_add_u32 m0, s73, 123904
    s_nop 0
    buffer_load_dwordx4 v3, s[28:31], s38 offen lds
    s_add_u32 s38, s37, 0
    s_add_u32 m0, s73, 124928
    s_nop 0
    buffer_load_dwordx4 v4, s[28:31], s38 offen lds
    s_add_u32 s38, s37, 21504
    s_add_u32 m0, s73, 125952
    s_nop 0
    buffer_load_dwordx4 v2, s[28:31], s38 offen lds
    s_add_u32 s38, s37, 21504
    s_add_u32 m0, s73, 126976
    s_nop 0
    buffer_load_dwordx4 v3, s[28:31], s38 offen lds
    s_add_u32 s38, s37, 21504
    s_add_u32 m0, s73, 128000
    s_nop 0
    buffer_load_dwordx4 v4, s[28:31], s38 offen lds
    s_add_u32 s38, s36, 0
    s_add_u32 m0, s72, 122880
    s_nop 0
    buffer_load_dwordx4 v5, s[24:27], s38 offen lds
    s_add_u32 s38, s36, 7168
    s_add_u32 m0, s72, 123904
    s_nop 0
    buffer_load_dwordx4 v6, s[24:27], s38 offen lds
    s_add_u32 s38, s36, 14336
    s_add_u32 m0, s72, 124928
    s_nop 0
    buffer_load_dwordx4 v5, s[24:27], s38 offen lds
    s_add_u32 s38, s36, 21504
    s_add_u32 m0, s72, 125952
    s_nop 0
    buffer_load_dwordx4 v6, s[24:27], s38 offen lds
    s_waitcnt vmcnt(10)
    s_barrier
    s_lshl_b32 s36, s74, 7
    s_add_u32 s36, s36, s70
    s_mul_i32 s37, s74, 172032
    s_add_u32 s37, s37, s71
    s_add_u32 s74, s74, 1
    s_cmp_eq_u32 s74, 7
    s_cselect_b32 s74, 0, s74
    s_add_u32 s38, s37, 0
    s_add_u32 m0, s73, 0
    s_nop 0
    buffer_load_dwordx4 v2, s[28:31], s38 offen lds
    s_add_u32 s38, s37, 0
    s_add_u32 m0, s73, 1024
    s_nop 0
    buffer_load_dwordx4 v3, s[28:31], s38 offen lds
    s_add_u32 s38, s37, 0
    s_add_u32 m0, s73, 2048
    s_nop 0
    buffer_load_dwordx4 v4, s[28:31], s38 offen lds
    s_add_u32 s38, s37, 21504
    s_add_u32 m0, s73, 3072
    s_nop 0
    buffer_load_dwordx4 v2, s[28:31], s38 offen lds
    s_add_u32 s38, s37, 21504
    s_add_u32 m0, s73, 4096
    s_nop 0
    buffer_load_dwordx4 v3, s[28:31], s38 offen lds
    s_add_u32 s38, s37, 21504
    s_add_u32 m0, s73, 5120
    s_nop 0
    buffer_load_dwordx4 v4, s[28:31], s38 offen lds
    s_add_u32 s38, s36, 0
    s_add_u32 m0, s72, 0
    s_nop 0
    buffer_load_dwordx4 v5, s[24:27], s38 offen lds
    s_add_u32 s38, s36, 7168
    s_add_u32 m0, s72, 1024
    s_nop 0
    buffer_load_dwordx4 v6, s[24:27], s38 offen lds
    s_add_u32 s38, s36, 14336
    s_add_u32 m0, s72, 2048
    s_nop 0
    buffer_load_dwordx4 v5, s[24:27], s38 offen lds
    s_add_u32 s38, s36, 21504
    s_add_u32 m0, s72, 3072
    s_nop 0
    buffer_load_dwordx4 v6, s[24:27], s38 offen lds
    s_waitcnt vmcnt(10)
    s_barrier
    s_lshl_b32 s36, s74, 7
    s_add_u32 s36, s36, s70
    s_mul_i32 s37, s74, 172032
    s_add_u32 s37, s37, s71
    s_add_u32 s74, s74, 1
    s_cmp_eq_u32 s74, 7
    s_cselect_b32 s74, 0, s74
    s_add_u32 s38, s37, 0
    s_add_u32 m0, s73, 40960
    s_nop 0
    buffer_load_dwordx4 v2, s[28:31], s38 offen lds
    s_add_u32 s38, s37, 0
    s_add_u32 m0, s73, 41984
    s_nop 0
    buffer_load_dwordx4 v3, s[28:31], s38 offen lds
    s_add_u32 s38, s37, 0
    s_add_u32 m0, s73, 43008
    s_nop 0
    buffer_load_dwordx4 v4, s[28:31], s38 offen lds
    s_add_u32 s38, s37, 21504
    s_add_u32 m0, s73, 44032
    s_nop 0
    buffer_load_dwordx4 v2, s[28:31], s38 offen lds
    s_add_u32 s38, s37, 21504
    s_add_u32 m0, s73, 45056
    s_nop 0
    buffer_load_dwordx4 v3, s[28:31], s38 offen lds
    s_add_u32 s38, s37, 21504
    s_add_u32 m0, s73, 46080
    s_nop 0
    buffer_load_dwordx4 v4, s[28:31], s38 offen lds
    s_add_u32 s38, s36, 0
    s_add_u32 m0, s72, 40960
    s_nop 0
    buffer_load_dwordx4 v5, s[24:27], s38 offen lds
    s_add_u32 s38, s36, 7168
    s_add_u32 m0, s72, 41984
    s_nop 0
    buffer_load_dwordx4 v6, s[24:27], s38 offen lds
    s_add_u32 s38, s36, 14336
    s_add_u32 m0, s72, 43008
    s_nop 0
    buffer_load_dwordx4 v5, s[24:27], s38 offen lds
    s_add_u32 s38, s36, 21504
    s_add_u32 m0, s72, 44032
    s_nop 0
    buffer_load_dwordx4 v6, s[24:27], s38 offen lds
    s_waitcnt vmcnt(10)
    s_barrier
    s_lshl_b32 s36, s74, 7
    s_add_u32 s36, s36, s70
    s_mul_i32 s37, s74, 172032
    s_add_u32 s37, s37, s71
    s_add_u32 s74, s74, 1
    s_cmp_eq_u32 s74, 7
    s_cselect_b32 s74, 0, s74
    s_add_u32 s38, s37, 0
    s_add_u32 m0, s73, 81920
    s_nop 0
    buffer_load_dwordx4 v2, s[28:31], s38 offen lds
    s_add_u32 s38, s37, 0
    s_add_u32 m0, s73, 82944
    s_nop 0
    buffer_load_dwordx4 v3, s[28:31], s38 offen lds
    s_add_u32 s38, s37, 0
    s_add_u32 m0, s73, 83968
    s_nop 0
    buffer_load_dwordx4 v4, s[28:31], s38 offen lds
    s_add_u32 s38, s37, 21504
    s_add_u32 m0, s73, 84992
    s_nop 0
    buffer_load_dwordx4 v2, s[28:31], s38 offen lds
    s_add_u32 s38, s37, 21504
    s_add_u32 m0, s73, 86016
    s_nop 0
    buffer_load_dwordx4 v3, s[28:31], s38 offen lds
    s_add_u32 s38, s37, 21504
    s_add_u32 m0, s73, 87040
    s_nop 0
    buffer_load_dwordx4 v4, s[28:31], s38 offen lds
    s_add_u32 s38, s36, 0
    s_add_u32 m0, s72, 81920
    s_nop 0
    buffer_load_dwordx4 v5, s[24:27], s38 offen lds
    s_add_u32 s38, s36, 7168
    s_add_u32 m0, s72, 82944
    s_nop 0
    buffer_load_dwordx4 v6, s[24:27], s38 offen lds
    s_add_u32 s38, s36, 14336
    s_add_u32 m0, s72, 83968
    s_nop 0
    buffer_load_dwordx4 v5, s[24:27], s38 offen lds
    s_add_u32 s38, s36, 21504
    s_add_u32 m0, s72, 84992
    s_nop 0
    buffer_load_dwordx4 v6, s[24:27], s38 offen lds
    s_waitcnt vmcnt(10)
    s_barrier
    s_waitcnt vmcnt(0)
    s_barrier
    s_endpgm
K1_COMPUTE:
    s_and_b32 s36, s23, 1
    s_lshl_b32 s36, s36, 13
    v_and_b32 v12, 31, v1
    v_lshrrev_b32 v13, 5, v1
    v_lshrrev_b32 v14, 1, v12
    v_and_b32 v14, 7, v14
    v_xor_b32 v14, v14, v13
    v_lshlrev_b32 v14, 4, v14
    v_lshlrev_b32 v15, 7, v12
    v_add3_u32 v7, v15, v14, s36
    v_xor_b32 v8, 32, v7
    v_xor_b32 v9, 64, v7
    v_xor_b32 v10, 96, v7
    s_lshr_b32 s36, s23, 1
    s_mul_i32 s36, s36, 3
    v_lshrrev_b32 v13, 5, v1
    v_lshlrev_b32 v13, 3, v13
    v_and_b32 v14, 15, v1
    v_lshrrev_b32 v15, 2, v14
    v_add_u32 v13, v13, v15
    v_mul_u32_u24 v13, 384, v13
    v_lshrrev_b32 v15, 4, v1
    v_and_b32 v15, 1, v15
    v_lshlrev_b32 v15, 5, v15
    v_and_b32 v12, 3, v14
    v_lshlrev_b32 v12, 3, v12
    v_add3_u32 v13, v13, v15, v12
    v_add_u32 v13, 16384, v13
    v_lshrrev_b32 v14, 3, v14
    s_add_u32 s37, s36, 0
    v_xor_b32 v12, s37, v14
    v_lshlrev_b32 v12, 6, v12
    v_add_u32 v11, v13, v12
    v_add_u32 v160, 0, v11
    v_add_u32 v163, 40960, v11
    v_add_u32 v166, 81920, v11
    v_add_u32 v169, 122880, v11
    s_add_u32 s37, s36, 1
    v_xor_b32 v12, s37, v14
    v_lshlrev_b32 v12, 6, v12
    v_add_u32 v11, v13, v12
    v_add_u32 v161, 0, v11
    v_add_u32 v164, 40960, v11
    v_add_u32 v167, 81920, v11
    v_add_u32 v170, 122880, v11
    s_add_u32 s37, s36, 2
    v_xor_b32 v12, s37, v14
    v_lshlrev_b32 v12, 6, v12
    v_add_u32 v11, v13, v12
    v_add_u32 v162, 0, v11
    v_add_u32 v165, 40960, v11
    v_add_u32 v168, 81920, v11
    v_add_u32 v171, 122880, v11
    v_add_u32 v172, 0, v7
    v_add_u32 v173, 0, v8
    v_add_u32 v174, 0, v9
    v_add_u32 v175, 0, v10
    v_add_u32 v176, 40960, v7
    v_add_u32 v177, 40960, v8
    v_add_u32 v178, 40960, v9
    v_add_u32 v179, 40960, v10
    v_add_u32 v180, 81920, v7
    v_add_u32 v181, 81920, v8
    v_add_u32 v182, 81920, v9
    v_add_u32 v183, 81920, v10
    v_add_u32 v184, 122880, v7
    v_add_u32 v185, 122880, v8
    v_add_u32 v186, 122880, v9
    v_add_u32 v187, 122880, v10
    s_waitcnt lgkmcnt(0)
    s_mov_b32 s32, s16
    s_and_b32 s33, s17, 0xffff
    s_mov_b32 s34, 14684160
    s_mov_b32 s35, 0x20000
    v_lshlrev_b32 v2, 3, v1
    s_lshl_b32 s36, s20, 6
    s_lshl_b32 s37, s21, 2
    s_add_u32 s36, s36, s37
    s_and_b32 s37, s23, 1
    s_lshl_b32 s37, s37, 1
    s_add_u32 s36, s36, s37
    s_mul_i32 s36, s36, 86016
    s_lshr_b32 s37, s23, 1
    s_mul_i32 s37, s37, 3
    s_mul_i32 s38, s22, 6
    s_add_u32 s37, s37, s38
    s_lshl_b32 s37, s37, 11
    s_add_u32 s36, s36, s37
    s_barrier
    ds_read_b128 v[112:115], v172
    ds_read_b64_tr_b16 v[128:129], v160 offset:0
    ds_read_b64_tr_b16 v[130:131], v160 offset:1536
    ds_read_b64_tr_b16 v[132:133], v161 offset:0
    ds_read_b64_tr_b16 v[134:135], v161 offset:1536
    ds_read_b64_tr_b16 v[136:137], v162 offset:0
    ds_read_b64_tr_b16 v[138:139], v162 offset:1536
    ds_read_b128 v[116:119], v172 offset:4096
    s_waitcnt lgkmcnt(0)
    v_mfma_f32_32x32x16_bf16 v[16:31], v[128:131], v[112:115], 0
    ds_read_b128 v[120:123], v173
    ds_read_b64_tr_b16 v[140:141], v160 offset:6144
    v_mfma_f32_32x32x16_bf16 v[32:47], v[132:135], v[112:115], 0
    ds_read_b64_tr_b16 v[142:143], v160 offset:7680
    ds_read_b64_tr_b16 v[144:145], v161 offset:6144
    v_mfma_f32_32x32x16_bf16 v[48:63], v[136:139], v[112:115], 0
    ds_read_b64_tr_b16 v[146:147], v161 offset:7680
    ds_read_b64_tr_b16 v[148:149], v162 offset:6144
    v_mfma_f32_32x32x16_bf16 v[64:79], v[128:131], v[116:119], 0
    ds_read_b64_tr_b16 v[150:151], v162 offset:7680
    ds_read_b128 v[124:127], v173 offset:4096
    v_mfma_f32_32x32x16_bf16 v[80:95], v[132:135], v[116:119], 0
    v_mfma_f32_32x32x16_bf16 v[96:111], v[136:139], v[116:119], 0
    s_waitcnt lgkmcnt(0)
    v_mfma_f32_32x32x16_bf16 v[16:31], v[140:143], v[120:123], v[16:31]
    ds_read_b128 v[112:115], v174
    ds_read_b64_tr_b16 v[128:129], v160 offset:12288
    v_mfma_f32_32x32x16_bf16 v[32:47], v[144:147], v[120:123], v[32:47]
    ds_read_b64_tr_b16 v[130:131], v160 offset:13824
    ds_read_b64_tr_b16 v[132:133], v161 offset:12288
    v_mfma_f32_32x32x16_bf16 v[48:63], v[148:151], v[120:123], v[48:63]
    ds_read_b64_tr_b16 v[134:135], v161 offset:13824
    ds_read_b64_tr_b16 v[136:137], v162 offset:12288
    v_mfma_f32_32x32x16_bf16 v[64:79], v[140:143], v[124:127], v[64:79]
    ds_read_b64_tr_b16 v[138:139], v162 offset:13824
    ds_read_b128 v[116:119], v174 offset:4096
    v_mfma_f32_32x32x16_bf16 v[80:95], v[144:147], v[124:127], v[80:95]
    v_mfma_f32_32x32x16_bf16 v[96:111], v[148:151], v[124:127], v[96:111]
    s_barrier
    s_waitcnt lgkmcnt(0)
    v_mfma_f32_32x32x16_bf16 v[16:31], v[128:131], v[112:115], v[16:31]
    ds_read_b128 v[120:123], v175
    ds_read_b64_tr_b16 v[140:141], v160 offset:18432
    v_mfma_f32_32x32x16_bf16 v[32:47], v[132:135], v[112:115], v[32:47]
    ds_read_b64_tr_b16 v[142:143], v160 offset:19968
    ds_read_b64_tr_b16 v[144:145], v161 offset:18432
    v_mfma_f32_32x32x16_bf16 v[48:63], v[136:139], v[112:115], v[48:63]
    ds_read_b64_tr_b16 v[146:147], v161 offset:19968
    ds_read_b64_tr_b16 v[148:149], v162 offset:18432
    v_mfma_f32_32x32x16_bf16 v[64:79], v[128:131], v[116:119], v[64:79]
    ds_read_b64_tr_b16 v[150:151], v162 offset:19968
    ds_read_b128 v[124:127], v175 offset:4096
    v_mfma_f32_32x32x16_bf16 v[80:95], v[132:135], v[116:119], v[80:95]
    v_mfma_f32_32x32x16_bf16 v[96:111], v[136:139], v[116:119], v[96:111]
    s_waitcnt lgkmcnt(0)
    v_mfma_f32_32x32x16_bf16 v[16:31], v[140:143], v[120:123], v[16:31]
    ds_read_b128 v[112:115], v176
    ds_read_b64_tr_b16 v[128:129], v163 offset:0
    v_mfma_f32_32x32x16_bf16 v[32:47], v[144:147], v[120:123], v[32:47]
    ds_read_b64_tr_b16 v[130:131], v163 offset:1536
    ds_read_b64_tr_b16 v[132:133], v164 offset:0
    v_mfma_f32_32x32x16_bf16 v[48:63], v[148:151], v[120:123], v[48:63]
    ds_read_b64_tr_b16 v[134:135], v164 offset:1536
    ds_read_b64_tr_b16 v[136:137], v165 offset:0
    v_mfma_f32_32x32x16_bf16 v[64:79], v[140:143], v[124:127], v[64:79]
    ds_read_b64_tr_b16 v[138:139], v165 offset:1536
    ds_read_b128 v[116:119], v176 offset:4096
    v_mfma_f32_32x32x16_bf16 v[80:95], v[144:147], v[124:127], v[80:95]
    v_mfma_f32_32x32x16_bf16 v[96:111], v[148:151], v[124:127], v[96:111]
    s_waitcnt lgkmcnt(0)
    v_mfma_f32_32x32x16_bf16 v[16:31], v[128:131], v[112:115], v[16:31]
    ds_read_b128 v[120:123], v177
    ds_read_b64_tr_b16 v[140:141], v163 offset:6144
    v_mfma_f32_32x32x16_bf16 v[32:47], v[132:135], v[112:115], v[32:47]
    ds_read_b64_tr_b16 v[142:143], v163 offset:7680
    ds_read_b64_tr_b16 v[144:145], v164 offset:6144
    v_mfma_f32_32x32x16_bf16 v[48:63], v[136:139], v[112:115], v[48:63]
    ds_read_b64_tr_b16 v[146:147], v164 offset:7680
    ds_read_b64_tr_b16 v[148:149], v165 offset:6144
    v_mfma_f32_32x32x16_bf16 v[64:79], v[128:131], v[116:119], v[64:79]
    ds_read_b64_tr_b16 v[150:151], v165 offset:7680
    ds_read_b128 v[124:127], v177 offset:4096
    v_mfma_f32_32x32x16_bf16 v[80:95], v[132:135], v[116:119], v[80:95]
    v_mfma_f32_32x32x16_bf16 v[96:111], v[136:139], v[116:119], v[96:111]
    s_waitcnt lgkmcnt(0)
    v_mfma_f32_32x32x16_bf16 v[16:31], v[140:143], v[120:123], v[16:31]
    ds_read_b128 v[112:115], v178
    ds_read_b64_tr_b16 v[128:129], v163 offset:12288
    v_mfma_f32_32x32x16_bf16 v[32:47], v[144:147], v[120:123], v[32:47]
    ds_read_b64_tr_b16 v[130:131], v163 offset:13824
    ds_read_b64_tr_b16 v[132:133], v164 offset:12288
    v_mfma_f32_32x32x16_bf16 v[48:63], v[148:151], v[120:123], v[48:63]
    ds_read_b64_tr_b16 v[134:135], v164 offset:13824
    ds_read_b64_tr_b16 v[136:137], v165 offset:12288
    v_mfma_f32_32x32x16_bf16 v[64:79], v[140:143], v[124:127], v[64:79]
    ds_read_b64_tr_b16 v[138:139], v165 offset:13824
    ds_read_b128 v[116:119], v178 offset:4096
    v_mfma_f32_32x32x16_bf16 v[80:95], v[144:147], v[124:127], v[80:95]
    v_mfma_f32_32x32x16_bf16 v[96:111], v[148:151], v[124:127], v[96:111]
    s_barrier
    s_waitcnt lgkmcnt(0)
    v_mfma_f32_32x32x16_bf16 v[16:31], v[128:131], v[112:115], v[16:31]
    ds_read_b128 v[120:123], v179
    ds_read_b64_tr_b16 v[140:141], v163 offset:18432
    v_mfma_f32_32x32x16_bf16 v[32:47], v[132:135], v[112:115], v[32:47]
    ds_read_b64_tr_b16 v[142:143], v163 offset:19968
    ds_read_b64_tr_b16 v[144:145], v164 offset:18432
    v_mfma_f32_32x32x16_bf16 v[48:63], v[136:139], v[112:115], v[48:63]
    ds_read_b64_tr_b16 v[146:147], v164 offset:19968
    ds_read_b64_tr_b16 v[148:149], v165 offset:18432
    v_mfma_f32_32x32x16_bf16 v[64:79], v[128:131], v[116:119], v[64:79]
    ds_read_b64_tr_b16 v[150:151], v165 offset:19968
    ds_read_b128 v[124:127], v179 offset:4096
    v_mfma_f32_32x32x16_bf16 v[80:95], v[132:135], v[116:119], v[80:95]
    v_mfma_f32_32x32x16_bf16 v[96:111], v[136:139], v[116:119], v[96:111]
    s_waitcnt lgkmcnt(0)
    v_mfma_f32_32x32x16_bf16 v[16:31], v[140:143], v[120:123], v[16:31]
    ds_read_b128 v[112:115], v180
    ds_read_b64_tr_b16 v[128:129], v166 offset:0
    v_mfma_f32_32x32x16_bf16 v[32:47], v[144:147], v[120:123], v[32:47]
    ds_read_b64_tr_b16 v[130:131], v166 offset:1536
    ds_read_b64_tr_b16 v[132:133], v167 offset:0
    v_mfma_f32_32x32x16_bf16 v[48:63], v[148:151], v[120:123], v[48:63]
    ds_read_b64_tr_b16 v[134:135], v167 offset:1536
    ds_read_b64_tr_b16 v[136:137], v168 offset:0
    v_mfma_f32_32x32x16_bf16 v[64:79], v[140:143], v[124:127], v[64:79]
    ds_read_b64_tr_b16 v[138:139], v168 offset:1536
    ds_read_b128 v[116:119], v180 offset:4096
    v_mfma_f32_32x32x16_bf16 v[80:95], v[144:147], v[124:127], v[80:95]
    v_mfma_f32_32x32x16_bf16 v[96:111], v[148:151], v[124:127], v[96:111]
    s_waitcnt lgkmcnt(0)
    v_mfma_f32_32x32x16_bf16 v[16:31], v[128:131], v[112:115], v[16:31]
    ds_read_b128 v[120:123], v181
    ds_read_b64_tr_b16 v[140:141], v166 offset:6144
    v_mfma_f32_32x32x16_bf16 v[32:47], v[132:135], v[112:115], v[32:47]
    ds_read_b64_tr_b16 v[142:143], v166 offset:7680
    ds_read_b64_tr_b16 v[144:145], v167 offset:6144
    v_mfma_f32_32x32x16_bf16 v[48:63], v[136:139], v[112:115], v[48:63]
    ds_read_b64_tr_b16 v[146:147], v167 offset:7680
    ds_read_b64_tr_b16 v[148:149], v168 offset:6144
    v_mfma_f32_32x32x16_bf16 v[64:79], v[128:131], v[116:119], v[64:79]
    ds_read_b64_tr_b16 v[150:151], v168 offset:7680
    ds_read_b128 v[124:127], v181 offset:4096
    v_mfma_f32_32x32x16_bf16 v[80:95], v[132:135], v[116:119], v[80:95]
    v_mfma_f32_32x32x16_bf16 v[96:111], v[136:139], v[116:119], v[96:111]
    s_waitcnt lgkmcnt(0)
    v_mfma_f32_32x32x16_bf16 v[16:31], v[140:143], v[120:123], v[16:31]
    ds_read_b128 v[112:115], v182
    ds_read_b64_tr_b16 v[128:129], v166 offset:12288
    v_mfma_f32_32x32x16_bf16 v[32:47], v[144:147], v[120:123], v[32:47]
    ds_read_b64_tr_b16 v[130:131], v166 offset:13824
    ds_read_b64_tr_b16 v[132:133], v167 offset:12288
    v_mfma_f32_32x32x16_bf16 v[48:63], v[148:151], v[120:123], v[48:63]
    ds_read_b64_tr_b16 v[134:135], v167 offset:13824
    ds_read_b64_tr_b16 v[136:137], v168 offset:12288
    v_mfma_f32_32x32x16_bf16 v[64:79], v[140:143], v[124:127], v[64:79]
    ds_read_b64_tr_b16 v[138:139], v168 offset:13824
    ds_read_b128 v[116:119], v182 offset:4096
    v_mfma_f32_32x32x16_bf16 v[80:95], v[144:147], v[124:127], v[80:95]
    v_mfma_f32_32x32x16_bf16 v[96:111], v[148:151], v[124:127], v[96:111]
    s_barrier
    s_waitcnt lgkmcnt(0)
    v_mfma_f32_32x32x16_bf16 v[16:31], v[128:131], v[112:115], v[16:31]
    ds_read_b128 v[120:123], v183
    ds_read_b64_tr_b16 v[140:141], v166 offset:18432
    v_mfma_f32_32x32x16_bf16 v[32:47], v[132:135], v[112:115], v[32:47]
    ds_read_b64_tr_b16 v[142:143], v166 offset:19968
    ds_read_b64_tr_b16 v[144:145], v167 offset:18432
    v_mfma_f32_32x32x16_bf16 v[48:63], v[136:139], v[112:115], v[48:63]
    ds_read_b64_tr_b16 v[146:147], v167 offset:19968
    ds_read_b64_tr_b16 v[148:149], v168 offset:18432
    v_mfma_f32_32x32x16_bf16 v[64:79], v[128:131], v[116:119], v[64:79]
    ds_read_b64_tr_b16 v[150:151], v168 offset:19968
    ds_read_b128 v[124:127], v183 offset:4096
    v_mfma_f32_32x32x16_bf16 v[80:95], v[132:135], v[116:119], v[80:95]
    v_mfma_f32_32x32x16_bf16 v[96:111], v[136:139], v[116:119], v[96:111]
    s_waitcnt lgkmcnt(0)
    v_mfma_f32_32x32x16_bf16 v[16:31], v[140:143], v[120:123], v[16:31]
    ds_read_b128 v[112:115], v184
    ds_read_b64_tr_b16 v[128:129], v169 offset:0
    v_mfma_f32_32x32x16_bf16 v[32:47], v[144:147], v[120:123], v[32:47]
    ds_read_b64_tr_b16 v[130:131], v169 offset:1536
    ds_read_b64_tr_b16 v[132:133], v170 offset:0
    v_mfma_f32_32x32x16_bf16 v[48:63], v[148:151], v[120:123], v[48:63]
    ds_read_b64_tr_b16 v[134:135], v170 offset:1536
    ds_read_b64_tr_b16 v[136:137], v171 offset:0
    v_mfma_f32_32x32x16_bf16 v[64:79], v[140:143], v[124:127], v[64:79]
    ds_read_b64_tr_b16 v[138:139], v171 offset:1536
    ds_read_b128 v[116:119], v184 offset:4096
    v_mfma_f32_32x32x16_bf16 v[80:95], v[144:147], v[124:127], v[80:95]
    v_mfma_f32_32x32x16_bf16 v[96:111], v[148:151], v[124:127], v[96:111]
    s_waitcnt lgkmcnt(0)
    v_mfma_f32_32x32x16_bf16 v[16:31], v[128:131], v[112:115], v[16:31]
    ds_read_b128 v[120:123], v185
    ds_read_b64_tr_b16 v[140:141], v169 offset:6144
    v_mfma_f32_32x32x16_bf16 v[32:47], v[132:135], v[112:115], v[32:47]
    ds_read_b64_tr_b16 v[142:143], v169 offset:7680
    ds_read_b64_tr_b16 v[144:145], v170 offset:6144
    v_mfma_f32_32x32x16_bf16 v[48:63], v[136:139], v[112:115], v[48:63]
    ds_read_b64_tr_b16 v[146:147], v170 offset:7680
    ds_read_b64_tr_b16 v[148:149], v171 offset:6144
    v_mfma_f32_32x32x16_bf16 v[64:79], v[128:131], v[116:119], v[64:79]
    ds_read_b64_tr_b16 v[150:151], v171 offset:7680
    ds_read_b128 v[124:127], v185 offset:4096
    v_mfma_f32_32x32x16_bf16 v[80:95], v[132:135], v[116:119], v[80:95]
    v_mfma_f32_32x32x16_bf16 v[96:111], v[136:139], v[116:119], v[96:111]
    s_waitcnt lgkmcnt(0)
    v_mfma_f32_32x32x16_bf16 v[16:31], v[140:143], v[120:123], v[16:31]
    ds_read_b128 v[112:115], v186
    ds_read_b64_tr_b16 v[128:129], v169 offset:12288
    v_mfma_f32_32x32x16_bf16 v[32:47], v[144:147], v[120:123], v[32:47]
    ds_read_b64_tr_b16 v[130:131], v169 offset:13824
    ds_read_b64_tr_b16 v[132:133], v170 offset:12288
    v_mfma_f32_32x32x16_bf16 v[48:63], v[148:151], v[120:123], v[48:63]
    ds_read_b64_tr_b16 v[134:135], v170 offset:13824
    ds_read_b64_tr_b16 v[136:137], v171 offset:12288
    v_mfma_f32_32x32x16_bf16 v[64:79], v[140:143], v[124:127], v[64:79]
    ds_read_b64_tr_b16 v[138:139], v171 offset:13824
    ds_read_b128 v[116:119], v186 offset:4096
    v_mfma_f32_32x32x16_bf16 v[80:95], v[144:147], v[124:127], v[80:95]
    v_mfma_f32_32x32x16_bf16 v[96:111], v[148:151], v[124:127], v[96:111]
    s_barrier
    s_waitcnt lgkmcnt(0)
    v_mfma_f32_32x32x16_bf16 v[16:31], v[128:131], v[112:115], v[16:31]
    ds_read_b128 v[120:123], v187
    ds_read_b64_tr_b16 v[140:141], v169 offset:18432
    v_mfma_f32_32x32x16_bf16 v[32:47], v[132:135], v[112:115], v[32:47]
    ds_read_b64_tr_b16 v[142:143], v169 offset:19968
    ds_read_b64_tr_b16 v[144:145], v170 offset:18432
    v_mfma_f32_32x32x16_bf16 v[48:63], v[136:139], v[112:115], v[48:63]
    ds_read_b64_tr_b16 v[146:147], v170 offset:19968
    ds_read_b64_tr_b16 v[148:149], v171 offset:18432
    v_mfma_f32_32x32x16_bf16 v[64:79], v[128:131], v[116:119], v[64:79]
    ds_read_b64_tr_b16 v[150:151], v171 offset:19968
    ds_read_b128 v[124:127], v187 offset:4096
    v_mfma_f32_32x32x16_bf16 v[80:95], v[132:135], v[116:119], v[80:95]
    v_mfma_f32_32x32x16_bf16 v[96:111], v[136:139], v[116:119], v[96:111]
    s_waitcnt lgkmcnt(0)
    v_mfma_f32_32x32x16_bf16 v[16:31], v[140:143], v[120:123], v[16:31]
    ds_read_b128 v[112:115], v172
    ds_read_b64_tr_b16 v[128:129], v160 offset:0
    v_mfma_f32_32x32x16_bf16 v[32:47], v[144:147], v[120:123], v[32:47]
    ds_read_b64_tr_b16 v[130:131], v160 offset:1536
    ds_read_b64_tr_b16 v[132:133], v161 offset:0
    v_mfma_f32_32x32x16_bf16 v[48:63], v[148:151], v[120:123], v[48:63]
    ds_read_b64_tr_b16 v[134:135], v161 offset:1536
    ds_read_b64_tr_b16 v[136:137], v162 offset:0
    v_mfma_f32_32x32x16_bf16 v[64:79], v[140:143], v[124:127], v[64:79]
    ds_read_b64_tr_b16 v[138:139], v162 offset:1536
    ds_read_b128 v[116:119], v172 offset:4096
    v_mfma_f32_32x32x16_bf16 v[80:95], v[144:147], v[124:127], v[80:95]
    v_mfma_f32_32x32x16_bf16 v[96:111], v[148:151], v[124:127], v[96:111]
    s_waitcnt lgkmcnt(0)
    v_mfma_f32_32x32x16_bf16 v[16:31], v[128:131], v[112:115], v[16:31]
    ds_read_b128 v[120:123], v173
    ds_read_b64_tr_b16 v[140:141], v160 offset:6144
    v_mfma_f32_32x32x16_bf16 v[32:47], v[132:135], v[112:115], v[32:47]
    ds_read_b64_tr_b16 v[142:143], v160 offset:7680
    ds_read_b64_tr_b16 v[144:145], v161 offset:6144
    v_mfma_f32_32x32x16_bf16 v[48:63], v[136:139], v[112:115], v[48:63]
    ds_read_b64_tr_b16 v[146:147], v161 offset:7680
    ds_read_b64_tr_b16 v[148:149], v162 offset:6144
    v_mfma_f32_32x32x16_bf16 v[64:79], v[128:131], v[116:119], v[64:79]
    ds_read_b64_tr_b16 v[150:151], v162 offset:7680
    ds_read_b128 v[124:127], v173 offset:4096
    v_mfma_f32_32x32x16_bf16 v[80:95], v[132:135], v[116:119], v[80:95]
    v_mfma_f32_32x32x16_bf16 v[96:111], v[136:139], v[116:119], v[96:111]
    s_waitcnt lgkmcnt(0)
    v_mfma_f32_32x32x16_bf16 v[16:31], v[140:143], v[120:123], v[16:31]
    ds_read_b128 v[112:115], v174
    ds_read_b64_tr_b16 v[128:129], v160 offset:12288
    v_mfma_f32_32x32x16_bf16 v[32:47], v[144:147], v[120:123], v[32:47]
    ds_read_b64_tr_b16 v[130:131], v160 offset:13824
    ds_read_b64_tr_b16 v[132:133], v161 offset:12288
    v_mfma_f32_32x32x16_bf16 v[48:63], v[148:151], v[120:123], v[48:63]
    ds_read_b64_tr_b16 v[134:135], v161 offset:13824
    ds_read_b64_tr_b16 v[136:137], v162 offset:12288
    v_mfma_f32_32x32x16_bf16 v[64:79], v[140:143], v[124:127], v[64:79]
    ds_read_b64_tr_b16 v[138:139], v162 offset:13824
    ds_read_b128 v[116:119], v174 offset:4096
    v_mfma_f32_32x32x16_bf16 v[80:95], v[144:147], v[124:127], v[80:95]
    v_mfma_f32_32x32x16_bf16 v[96:111], v[148:151], v[124:127], v[96:111]
    s_barrier
    s_waitcnt lgkmcnt(0)
    v_mfma_f32_32x32x16_bf16 v[16:31], v[128:131], v[112:115], v[16:31]
    ds_read_b128 v[120:123], v175
    ds_read_b64_tr_b16 v[140:141], v160 offset:18432
    v_mfma_f32_32x32x16_bf16 v[32:47], v[132:135], v[112:115], v[32:47]
    ds_read_b64_tr_b16 v[142:143], v160 offset:19968
    ds_read_b64_tr_b16 v[144:145], v161 offset:18432
    v_mfma_f32_32x32x16_bf16 v[48:63], v[136:139], v[112:115], v[48:63]
    ds_read_b64_tr_b16 v[146:147], v161 offset:19968
    ds_read_b64_tr_b16 v[148:149], v162 offset:18432
    v_mfma_f32_32x32x16_bf16 v[64:79], v[128:131], v[116:119], v[64:79]
    ds_read_b64_tr_b16 v[150:151], v162 offset:19968
    ds_read_b128 v[124:127], v175 offset:4096
    v_mfma_f32_32x32x16_bf16 v[80:95], v[132:135], v[116:119], v[80:95]
    v_mfma_f32_32x32x16_bf16 v[96:111], v[136:139], v[116:119], v[96:111]
    s_waitcnt lgkmcnt(0)
    v_mfma_f32_32x32x16_bf16 v[16:31], v[140:143], v[120:123], v[16:31]
    ds_read_b128 v[112:115], v176
    ds_read_b64_tr_b16 v[128:129], v163 offset:0
    v_mfma_f32_32x32x16_bf16 v[32:47], v[144:147], v[120:123], v[32:47]
    ds_read_b64_tr_b16 v[130:131], v163 offset:1536
    ds_read_b64_tr_b16 v[132:133], v164 offset:0
    v_mfma_f32_32x32x16_bf16 v[48:63], v[148:151], v[120:123], v[48:63]
    ds_read_b64_tr_b16 v[134:135], v164 offset:1536
    ds_read_b64_tr_b16 v[136:137], v165 offset:0
    v_mfma_f32_32x32x16_bf16 v[64:79], v[140:143], v[124:127], v[64:79]
    ds_read_b64_tr_b16 v[138:139], v165 offset:1536
    ds_read_b128 v[116:119], v176 offset:4096
    v_mfma_f32_32x32x16_bf16 v[80:95], v[144:147], v[124:127], v[80:95]
    v_mfma_f32_32x32x16_bf16 v[96:111], v[148:151], v[124:127], v[96:111]
    s_waitcnt lgkmcnt(0)
    v_mfma_f32_32x32x16_bf16 v[16:31], v[128:131], v[112:115], v[16:31]
    ds_read_b128 v[120:123], v177
    ds_read_b64_tr_b16 v[140:141], v163 offset:6144
    v_mfma_f32_32x32x16_bf16 v[32:47], v[132:135], v[112:115], v[32:47]
    ds_read_b64_tr_b16 v[142:143], v163 offset:7680
    ds_read_b64_tr_b16 v[144:145], v164 offset:6144
    v_mfma_f32_32x32x16_bf16 v[48:63], v[136:139], v[112:115], v[48:63]
    ds_read_b64_tr_b16 v[146:147], v164 offset:7680
    ds_read_b64_tr_b16 v[148:149], v165 offset:6144
    v_mfma_f32_32x32x16_bf16 v[64:79], v[128:131], v[116:119], v[64:79]
    ds_read_b64_tr_b16 v[150:151], v165 offset:7680
    ds_read_b128 v[124:127], v177 offset:4096
    v_mfma_f32_32x32x16_bf16 v[80:95], v[132:135], v[116:119], v[80:95]
    v_mfma_f32_32x32x16_bf16 v[96:111], v[136:139], v[116:119], v[96:111]
    s_waitcnt lgkmcnt(0)
    v_mfma_f32_32x32x16_bf16 v[16:31], v[140:143], v[120:123], v[16:31]
    ds_read_b128 v[112:115], v178
    ds_read_b64_tr_b16 v[128:129], v163 offset:12288
    v_mfma_f32_32x32x16_bf16 v[32:47], v[144:147], v[120:123], v[32:47]
    ds_read_b64_tr_b16 v[130:131], v163 offset:13824
    ds_read_b64_tr_b16 v[132:133], v164 offset:12288
    v_mfma_f32_32x32x16_bf16 v[48:63], v[148:151], v[120:123], v[48:63]
    ds_read_b64_tr_b16 v[134:135], v164 offset:13824
    ds_read_b64_tr_b16 v[136:137], v165 offset:12288
    v_mfma_f32_32x32x16_bf16 v[64:79], v[140:143], v[124:127], v[64:79]
    ds_read_b64_tr_b16 v[138:139], v165 offset:13824
    ds_read_b128 v[116:119], v178 offset:4096
    v_mfma_f32_32x32x16_bf16 v[80:95], v[144:147], v[124:127], v[80:95]
    v_mfma_f32_32x32x16_bf16 v[96:111], v[148:151], v[124:127], v[96:111]
    s_barrier
    s_waitcnt lgkmcnt(0)
    v_mfma_f32_32x32x16_bf16 v[16:31], v[128:131], v[112:115], v[16:31]
    ds_read_b128 v[120:123], v179
    ds_read_b64_tr_b16 v[140:141], v163 offset:18432
    v_mfma_f32_32x32x16_bf16 v[32:47], v[132:135], v[112:115], v[32:47]
    ds_read_b64_tr_b16 v[142:143], v163 offset:19968
    ds_read_b64_tr_b16 v[144:145], v164 offset:18432
    v_mfma_f32_32x32x16_bf16 v[48:63], v[136:139], v[112:115], v[48:63]
    ds_read_b64_tr_b16 v[146:147], v164 offset:19968
    ds_read_b64_tr_b16 v[148:149], v165 offset:18432
    v_mfma_f32_32x32x16_bf16 v[64:79], v[128:131], v[116:119], v[64:79]
    ds_read_b64_tr_b16 v[150:151], v165 offset:19968
    ds_read_b128 v[124:127], v179 offset:4096
    v_mfma_f32_32x32x16_bf16 v[80:95], v[132:135], v[116:119], v[80:95]
    v_mfma_f32_32x32x16_bf16 v[96:111], v[136:139], v[116:119], v[96:111]
    s_waitcnt lgkmcnt(0)
    v_mfma_f32_32x32x16_bf16 v[16:31], v[140:143], v[120:123], v[16:31]
    ds_read_b128 v[112:115], v180
    ds_read_b64_tr_b16 v[128:129], v166 offset:0
    v_mfma_f32_32x32x16_bf16 v[32:47], v[144:147], v[120:123], v[32:47]
    ds_read_b64_tr_b16 v[130:131], v166 offset:1536
    ds_read_b64_tr_b16 v[132:133], v167 offset:0
    v_mfma_f32_32x32x16_bf16 v[48:63], v[148:151], v[120:123], v[48:63]
    ds_read_b64_tr_b16 v[134:135], v167 offset:1536
    ds_read_b64_tr_b16 v[136:137], v168 offset:0
    v_mfma_f32_32x32x16_bf16 v[64:79], v[140:143], v[124:127], v[64:79]
    ds_read_b64_tr_b16 v[138:139], v168 offset:1536
    ds_read_b128 v[116:119], v180 offset:4096
    v_mfma_f32_32x32x16_bf16 v[80:95], v[144:147], v[124:127], v[80:95]
    v_mfma_f32_32x32x16_bf16 v[96:111], v[148:151], v[124:127], v[96:111]
    s_waitcnt lgkmcnt(0)
    v_mfma_f32_32x32x16_bf16 v[16:31], v[128:131], v[112:115], v[16:31]
    ds_read_b128 v[120:123], v181
    ds_read_b64_tr_b16 v[140:141], v166 offset:6144
    v_mfma_f32_32x32x16_bf16 v[32:47], v[132:135], v[112:115], v[32:47]
    ds_read_b64_tr_b16 v[142:143], v166 offset:7680
    ds_read_b64_tr_b16 v[144:145], v167 offset:6144
    v_mfma_f32_32x32x16_bf16 v[48:63], v[136:139], v[112:115], v[48:63]
    ds_read_b64_tr_b16 v[146:147], v167 offset:7680
    ds_read_b64_tr_b16 v[148:149], v168 offset:6144
    v_mfma_f32_32x32x16_bf16 v[64:79], v[128:131], v[116:119], v[64:79]
    ds_read_b64_tr_b16 v[150:151], v168 offset:7680
    ds_read_b128 v[124:127], v181 offset:4096
    v_mfma_f32_32x32x16_bf16 v[80:95], v[132:135], v[116:119], v[80:95]
    v_mfma_f32_32x32x16_bf16 v[96:111], v[136:139], v[116:119], v[96:111]
    s_waitcnt lgkmcnt(0)
    v_mfma_f32_32x32x16_bf16 v[16:31], v[140:143], v[120:123], v[16:31]
    ds_read_b128 v[112:115], v182
    ds_read_b64_tr_b16 v[128:129], v166 offset:12288
    v_mfma_f32_32x32x16_bf16 v[32:47], v[144:147], v[120:123], v[32:47]
    ds_read_b64_tr_b16 v[130:131], v166 offset:13824
    ds_read_b64_tr_b16 v[132:133], v167 offset:12288
    v_mfma_f32_32x32x16_bf16 v[48:63], v[148:151], v[120:123], v[48:63]
    ds_read_b64_tr_b16 v[134:135], v167 offset:13824
    ds_read_b64_tr_b16 v[136:137], v168 offset:12288
    v_mfma_f32_32x32x16_bf16 v[64:79], v[140:143], v[124:127], v[64:79]
    ds_read_b64_tr_b16 v[138:139], v168 offset:13824
    ds_read_b128 v[116:119], v182 offset:4096
    v_mfma_f32_32x32x16_bf16 v[80:95], v[144:147], v[124:127], v[80:95]
    v_mfma_f32_32x32x16_bf16 v[96:111], v[148:151], v[124:127], v[96:111]
    s_waitcnt lgkmcnt(0)
    v_mfma_f32_32x32x16_bf16 v[16:31], v[128:131], v[112:115], v[16:31]
    ds_read_b128 v[120:123], v183
    ds_read_b64_tr_b16 v[140:141], v166 offset:18432
    v_mfma_f32_32x32x16_bf16 v[32:47], v[132:135], v[112:115], v[32:47]
    ds_read_b64_tr_b16 v[142:143], v166 offset:19968
    ds_read_b64_tr_b16 v[144:145], v167 offset:18432
    v_mfma_f32_32x32x16_bf16 v[48:63], v[136:139], v[112:115], v[48:63]
    ds_read_b64_tr_b16 v[146:147], v167 offset:19968
    ds_read_b64_tr_b16 v[148:149], v168 offset:18432
    v_mfma_f32_32x32x16_bf16 v[64:79], v[128:131], v[116:119], v[64:79]
    ds_read_b64_tr_b16 v[150:151], v168 offset:19968
    ds_read_b128 v[124:127], v183 offset:4096
    v_mfma_f32_32x32x16_bf16 v[80:95], v[132:135], v[116:119], v[80:95]
    v_mfma_f32_32x32x16_bf16 v[96:111], v[136:139], v[116:119], v[96:111]
    s_waitcnt lgkmcnt(0)
    v_mfma_f32_32x32x16_bf16 v[16:31], v[140:143], v[120:123], v[16:31]
    v_mfma_f32_32x32x16_bf16 v[32:47], v[144:147], v[120:123], v[32:47]
    v_mfma_f32_32x32x16_bf16 v[48:63], v[148:151], v[120:123], v[48:63]
    v_mfma_f32_32x32x16_bf16 v[64:79], v[140:143], v[124:127], v[64:79]
    v_mfma_f32_32x32x16_bf16 v[80:95], v[144:147], v[124:127], v[80:95]
    v_mfma_f32_32x32x16_bf16 v[96:111], v[148:151], v[124:127], v[96:111]
    s_nop 6
    v_cvt_pk_bf16_f32 v16, v16, v17
    v_cvt_pk_bf16_f32 v17, v18, v19
    v_cvt_pk_bf16_f32 v18, v20, v21
    v_cvt_pk_bf16_f32 v19, v22, v23
    v_cvt_pk_bf16_f32 v20, v24, v25
    v_cvt_pk_bf16_f32 v21, v26, v27
    v_cvt_pk_bf16_f32 v22, v28, v29
    v_cvt_pk_bf16_f32 v23, v30, v31
    s_add_u32 s37, s36, 0
    buffer_store_dwordx2 v[16:17], v2, s[32:35], s37 offen offset:0 sc1
    buffer_store_dwordx2 v[18:19], v2, s[32:35], s37 offen offset:512 sc1
    buffer_store_dwordx2 v[20:21], v2, s[32:35], s37 offen offset:1024 sc1
    buffer_store_dwordx2 v[22:23], v2, s[32:35], s37 offen offset:1536 sc1
    v_cvt_pk_bf16_f32 v32, v32, v33
    v_cvt_pk_bf16_f32 v33, v34, v35
    v_cvt_pk_bf16_f32 v34, v36, v37
    v_cvt_pk_bf16_f32 v35, v38, v39
    v_cvt_pk_bf16_f32 v36, v40, v41
    v_cvt_pk_bf16_f32 v37, v42, v43
    v_cvt_pk_bf16_f32 v38, v44, v45
    v_cvt_pk_bf16_f32 v39, v46, v47
    s_add_u32 s37, s36, 2048
    buffer_store_dwordx2 v[32:33], v2, s[32:35], s37 offen offset:0 sc1
    buffer_store_dwordx2 v[34:35], v2, s[32:35], s37 offen offset:512 sc1
    buffer_store_dwordx2 v[36:37], v2, s[32:35], s37 offen offset:1024 sc1
    buffer_store_dwordx2 v[38:39], v2, s[32:35], s37 offen offset:1536 sc1
    v_cvt_pk_bf16_f32 v48, v48, v49
    v_cvt_pk_bf16_f32 v49, v50, v51
    v_cvt_pk_bf16_f32 v50, v52, v53
    v_cvt_pk_bf16_f32 v51, v54, v55
    v_cvt_pk_bf16_f32 v52, v56, v57
    v_cvt_pk_bf16_f32 v53, v58, v59
    v_cvt_pk_bf16_f32 v54, v60, v61
    v_cvt_pk_bf16_f32 v55, v62, v63
    s_add_u32 s37, s36, 4096
    buffer_store_dwordx2 v[48:49], v2, s[32:35], s37 offen offset:0 sc1
    buffer_store_dwordx2 v[50:51], v2, s[32:35], s37 offen offset:512 sc1
    buffer_store_dwordx2 v[52:53], v2, s[32:35], s37 offen offset:1024 sc1
    buffer_store_dwordx2 v[54:55], v2, s[32:35], s37 offen offset:1536 sc1
    s_add_u32 s36, s36, 86016
    v_cvt_pk_bf16_f32 v64, v64, v65
    v_cvt_pk_bf16_f32 v65, v66, v67
    v_cvt_pk_bf16_f32 v66, v68, v69
    v_cvt_pk_bf16_f32 v67, v70, v71
    v_cvt_pk_bf16_f32 v68, v72, v73
    v_cvt_pk_bf16_f32 v69, v74, v75
    v_cvt_pk_bf16_f32 v70, v76, v77
    v_cvt_pk_bf16_f32 v71, v78, v79
    s_add_u32 s37, s36, 0
    buffer_store_dwordx2 v[64:65], v2, s[32:35], s37 offen offset:0 sc1
    buffer_store_dwordx2 v[66:67], v2, s[32:35], s37 offen offset:512 sc1
    buffer_store_dwordx2 v[68:69], v2, s[32:35], s37 offen offset:1024 sc1
    buffer_store_dwordx2 v[70:71], v2, s[32:35], s37 offen offset:1536 sc1
    v_cvt_pk_bf16_f32 v80, v80, v81
    v_cvt_pk_bf16_f32 v81, v82, v83
    v_cvt_pk_bf16_f32 v82, v84, v85
    v_cvt_pk_bf16_f32 v83, v86, v87
    v_cvt_pk_bf16_f32 v84, v88, v89
    v_cvt_pk_bf16_f32 v85, v90, v91
    v_cvt_pk_bf16_f32 v86, v92, v93
    v_cvt_pk_bf16_f32 v87, v94, v95
    s_add_u32 s37, s36, 2048
    buffer_store_dwordx2 v[80:81], v2, s[32:35], s37 offen offset:0 sc1
    buffer_store_dwordx2 v[82:83], v2, s[32:35], s37 offen offset:512 sc1
    buffer_store_dwordx2 v[84:85], v2, s[32:35], s37 offen offset:1024 sc1
    buffer_store_dwordx2 v[86:87], v2, s[32:35], s37 offen offset:1536 sc1
    v_cvt_pk_bf16_f32 v96, v96, v97
    v_cvt_pk_bf16_f32 v97, v98, v99
    v_cvt_pk_bf16_f32 v98, v100, v101
    v_cvt_pk_bf16_f32 v99, v102, v103
    v_cvt_pk_bf16_f32 v100, v104, v105
    v_cvt_pk_bf16_f32 v101, v106, v107
    v_cvt_pk_bf16_f32 v102, v108, v109
    v_cvt_pk_bf16_f32 v103, v110, v111
    s_add_u32 s37, s36, 4096
    buffer_store_dwordx2 v[96:97], v2, s[32:35], s37 offen offset:0 sc1
    buffer_store_dwordx2 v[98:99], v2, s[32:35], s37 offen offset:512 sc1
    buffer_store_dwordx2 v[100:101], v2, s[32:35], s37 offen offset:1024 sc1
    buffer_store_dwordx2 v[102:103], v2, s[32:35], s37 offen offset:1536 sc1
K1_END:
    s_endpgm
K1_HELP:
    s_cmp_ge_u32 s2, 232
    s_cbranch_scc1 K1_END
    s_getpc_b64 s[4:5]
K1_PC:
    s_sub_u32 s4, s4, K1_PC-fused_kernel
    s_subb_u32 s5, s5, 0
    v_lshlrev_b32 v1, 7, v0
    s_mov_b32 s6, CODE_END-fused_kernel-4
    v_min_u32 v1, s6, v1
    global_load_dword v2, v1, s[4:5]
    s_endpgm
.p2align 6
PH2:
    s_cmp_ge_u32 s2, 256
    s_cbranch_scc1 K2_END
    s_load_dwordx2 s[16:17], s[0:1], 64
    s_load_dwordx2 s[4:5], s[0:1], 16
    s_load_dwordx2 s[6:7], s[0:1], 40
    s_and_b32 s36, s2, 7
    s_lshr_b32 s37, s2, 3
    s_and_b32 s20, s36, 1
    s_and_b32 s38, s36, 6
    s_and_b32 s39, s37, 1
    s_add_u32 s21, s38, s39
    s_lshr_b32 s22, s37, 1
    v_lshrrev_b32 v2, 6, v0
    v_and_b32 v1, 63, v0
    v_and_b32 v13, 31, v1
    v_readfirstlane_b32 s23, v2
    v_lshrrev_b32 v14, 5, v1
    v_lshrrev_b32 v8, 4, v1
    v_and_b32 v9, 15, v1
    v_lshlrev_b32 v10, 1, v8
    v_xor_b32 v10, v9, v10
    v_lshlrev_b32 v10, 4, v10
    v_lshl_add_u32 v4, v8, 8, v10
    v_xor_b32 v5, 0x80, v4
    v_add_u32 v5, 0x400, v5
    v_lshlrev_b32 v6, 3, v13
    v_lshl_add_u32 v6, v14, 9, v6
    s_waitcnt lgkmcnt(0)
    s_mov_b32 s32, s16
    s_and_b32 s33, s17, 0xffff
    s_mov_b32 s34, 14684160
    s_mov_b32 s35, 0x20000
    s_lshl_b32 s36, s20, 6
    s_lshl_b32 s37, s21, 3
    s_add_u32 s36, s36, s37
    s_mul_i32 s36, s36, 86016
    s_mul_i32 s37, s22, 1792
    s_add_u32 s36, s36, s37
    s_mul_i32 s37, s23, 172032
    s_add_u32 s38, s36, s37
    s_sub_u32 s38, s38, 659456
    s_lshl_b32 s37, s23, 12
    s_cmp_eq_u32 s21, 0
    s_cselect_b32 s40, 1, 0
    s_cmp_lt_u32 s23, 4
    s_cselect_b32 s41, 1, 0
    s_and_b32 s75, s40, s41
    s_cmp_eq_u32 s75, 1
    s_cbranch_scc1 K2_FILL
    s_add_u32 m0, s37, 0
    s_add_u32 s41, s38, 0
    buffer_load_dwordx4 v4, s[32:35], s41 offen lds
    s_add_u32 m0, s37, 1024
    s_add_u32 s41, s38, 0
    buffer_load_dwordx4 v5, s[32:35], s41 offen lds
    s_add_u32 m0, s37, 2048
    s_add_u32 s41, s38, 86016
    buffer_load_dwordx4 v4, s[32:35], s41 offen lds
    s_add_u32 m0, s37, 3072
    s_add_u32 s41, s38, 86016
    buffer_load_dwordx4 v5, s[32:35], s41 offen lds
    s_branch K2_Q
K2_FILL:
    v_mov_b32 v8, 0
    v_mov_b32 v9, 0
    v_mov_b32 v10, 0
    v_mov_b32 v11, 0
    v_lshlrev_b32 v12, 4, v1
    v_add_u32 v12, s37, v12
    ds_write_b128 v12, v[8:11] offset:0
    ds_write_b128 v12, v[8:11] offset:32768
    ds_write_b128 v12, v[8:11] offset:1024
    ds_write_b128 v12, v[8:11] offset:33792
    ds_write_b128 v12, v[8:11] offset:2048
    ds_write_b128 v12, v[8:11] offset:34816
    ds_write_b128 v12, v[8:11] offset:3072
    ds_write_b128 v12, v[8:11] offset:35840
    s_waitcnt lgkmcnt(0)
K2_Q:
    s_mul_i32 s39, s23, 86016
    s_add_u32 s39, s39, s36
    buffer_load_dwordx2 v[16:17], v6, s[32:35], s39 offen
    buffer_load_dwordx2 v[18:19], v6, s[32:35], s39 offen offset:256
    buffer_load_dwordx2 v[20:21], v6, s[32:35], s39 offen offset:1024
    buffer_load_dwordx2 v[22:23], v6, s[32:35], s39 offen offset:1280
    v_lshlrev_b32 v15, 2, v14
    v_sub_u32 v15, v13, v15
    v_cmp_le_i32 s[40:41], 0, v15
    v_cmp_le_i32 s[42:43], 1, v15
    v_cmp_le_i32 s[44:45], 2, v15
    v_cmp_le_i32 s[46:47], 3, v15
    v_cmp_le_i32 s[48:49], 8, v15
    v_cmp_le_i32 s[50:51], 9, v15
    v_cmp_le_i32 s[52:53], 10, v15
    v_cmp_le_i32 s[54:55], 11, v15
    v_cmp_le_i32 s[56:57], 16, v15
    v_cmp_le_i32 s[58:59], 17, v15
    v_cmp_le_i32 s[60:61], 18, v15
    v_cmp_le_i32 s[62:63], 19, v15
    v_cmp_le_i32 s[64:65], 24, v15
    v_cmp_le_i32 s[66:67], 25, v15
    v_cmp_le_i32 s[68:69], 26, v15
    v_cmp_le_i32 s[70:71], 27, v15
    v_lshrrev_b32 v8, 1, v13
    v_xor_b32 v8, 14, v8
    v_lshlrev_b32 v8, 4, v8
    v_and_b32 v9, 1, v13
    v_lshl_add_u32 v8, v9, 3, v8
    v_lshl_add_u32 v8, v14, 11, v8
    v_add_u32 v8, s37, v8
    s_cmp_eq_u32 s75, 1
    s_cselect_b32 s36, 0x3f80, 0
    v_mov_b32 v10, s36
    v_mov_b32 v11, 0
    v_mov_b32 v12, 0x3f80
    s_lshl_b32 s36, s23, 11
    v_lshrrev_b32 v2, 1, v13
    v_and_b32 v3, 1, v13
    v_lshlrev_b32 v3, 3, v3
    v_add_u32 v3, s36, v3
    v_lshl_add_u32 v7, v14, 1, 0
    v_lshlrev_b32 v9, 1, v7
    v_and_b32 v9, 15, v9
    v_xor_b32 v9, v9, v2
    v_lshlrev_b32 v9, 4, v9
    v_lshl_add_u32 v9, v7, 8, v9
    v_add_u32 v56, v9, v3
    v_lshl_add_u32 v7, v14, 1, 1
    v_lshlrev_b32 v9, 1, v7
    v_and_b32 v9, 15, v9
    v_xor_b32 v9, v9, v2
    v_lshlrev_b32 v9, 4, v9
    v_lshl_add_u32 v9, v7, 8, v9
    v_add_u32 v57, v9, v3
    v_lshl_add_u32 v7, v14, 1, 4
    v_lshlrev_b32 v9, 1, v7
    v_and_b32 v9, 15, v9
    v_xor_b32 v9, v9, v2
    v_lshlrev_b32 v9, 4, v9
    v_lshl_add_u32 v9, v7, 8, v9
    v_add_u32 v58, v9, v3
    v_lshl_add_u32 v7, v14, 1, 5
    v_lshlrev_b32 v9, 1, v7
    v_and_b32 v9, 15, v9
    v_xor_b32 v9, v9, v2
    v_lshlrev_b32 v9, 4, v9
    v_lshl_add_u32 v9, v7, 8, v9
    v_add_u32 v59, v9, v3
    v_and_b32 v2, 15, v1
    v_lshrrev_b32 v3, 4, v1
    v_and_b32 v3, 1, v3
    v_and_b32 v7, 3, v2
    v_lshl_add_u32 v3, v3, 2, v7
    v_lshrrev_b32 v2, 2, v2
    v_lshl_add_u32 v2, v14, 2, v2
    v_add_u32 v7, 0, v2
    v_lshrrev_b32 v9, 1, v7
    v_lshlrev_b32 v15, 1, v3
    v_xor_b32 v9, v9, v15
    v_lshlrev_b32 v9, 4, v9
    v_lshl_add_u32 v9, v3, 8, v9
    v_and_b32 v7, 1, v7
    v_lshl_add_u32 v9, v7, 3, v9
    v_add_u32 v60, s36, v9
    v_add_u32 v7, 8, v2
    v_lshrrev_b32 v9, 1, v7
    v_lshlrev_b32 v15, 1, v3
    v_xor_b32 v9, v9, v15
    v_lshlrev_b32 v9, 4, v9
    v_lshl_add_u32 v9, v3, 8, v9
    v_and_b32 v7, 1, v7
    v_lshl_add_u32 v9, v7, 3, v9
    v_add_u32 v61, s36, v9
    v_add_u32 v7, 16, v2
    v_lshrrev_b32 v9, 1, v7
    v_lshlrev_b32 v15, 1, v3
    v_xor_b32 v9, v9, v15
    v_lshlrev_b32 v9, 4, v9
    v_lshl_add_u32 v9, v3, 8, v9
    v_and_b32 v7, 1, v7
    v_lshl_add_u32 v9, v7, 3, v9
    v_add_u32 v62, s36, v9
    v_add_u32 v7, 24, v2
    v_lshrrev_b32 v9, 1, v7
    v_lshlrev_b32 v15, 1, v3
    v_xor_b32 v9, v9, v15
    v_lshlrev_b32 v9, 4, v9
    v_lshl_add_u32 v9, v3, 8, v9
    v_and_b32 v7, 1, v7
    v_lshl_add_u32 v9, v7, 3, v9
    v_add_u32 v63, s36, v9
    v_mov_b32 v64, 1069066811
    v_mov_b32 v65, 1069066811
    v_mov_b32 v70, 1044481167
    v_mov_b32 v71, 1044481167
    s_waitcnt vmcnt(0)
    ds_write_b64 v8, v[10:11] offset:1792
    s_mov_b32 exec_lo, 0
    v_mov_b32 v22, 0xdf80
    v_mov_b32 v23, 0
    s_mov_b64 exec, -1
    s_waitcnt lgkmcnt(0)
    s_barrier
    s_cmp_eq_u32 s75, 1
    s_cbranch_scc1 K2_NOV
    s_add_u32 m0, s37, 32768
    s_add_u32 s77, s38, 28672
    buffer_load_dwordx4 v4, s[32:35], s77 offen lds
    s_add_u32 m0, s37, 33792
    s_add_u32 s77, s38, 28672
    buffer_load_dwordx4 v5, s[32:35], s77 offen lds
    s_add_u32 m0, s37, 34816
    s_add_u32 s77, s38, 114688
    buffer_load_dwordx4 v4, s[32:35], s77 offen lds
    s_add_u32 m0, s37, 35840
    s_add_u32 s77, s38, 114688
    buffer_load_dwordx4 v5, s[32:35], s77 offen lds
K2_NOV:
    ds_read_b64 v[72:73], v56 offset:0
    ds_read_b64 v[74:75], v57 offset:0
    ds_read_b64 v[76:77], v58 offset:0
    ds_read_b64 v[78:79], v59 offset:0
    ds_read_b64 v[80:81], v56 offset:16384
    ds_read_b64 v[82:83], v57 offset:16384
    ds_read_b64 v[84:85], v58 offset:16384
    ds_read_b64 v[86:87], v59 offset:16384
    ds_read_b64 v[88:89], v56 offset:2048
    ds_read_b64 v[90:91], v57 offset:2048
    ds_read_b64 v[92:93], v58 offset:2048
    ds_read_b64 v[94:95], v59 offset:2048
    s_waitcnt lgkmcnt(8)
    v_mfma_f32_32x32x16_bf16 v[96:111], v[72:75], v[16:19], 0
    v_mfma_f32_32x32x16_bf16 v[96:111], v[76:79], v[20:23], v[96:111]
    ds_read_b64 v[72:73], v56 offset:4096
    ds_read_b64 v[74:75], v57 offset:4096
    ds_read_b64 v[76:77], v58 offset:4096
    ds_read_b64 v[78:79], v59 offset:4096
    s_waitcnt lgkmcnt(8)
    v_mfma_f32_32x32x16_bf16 v[224:239], v[80:83], v[16:19], 0
    v_mfma_f32_32x32x16_bf16 v[224:239], v[84:87], v[20:23], v[224:239]
    ds_read_b64 v[80:81], v56 offset:6144
    ds_read_b64 v[82:83], v57 offset:6144
    ds_read_b64 v[84:85], v58 offset:6144
    ds_read_b64 v[86:87], v59 offset:6144
    s_waitcnt lgkmcnt(8)
    v_mfma_f32_32x32x16_bf16 v[112:127], v[88:91], v[16:19], 0
    v_mfma_f32_32x32x16_bf16 v[112:127], v[92:95], v[20:23], v[112:127]
    ds_read_b64 v[88:89], v56 offset:8192
    ds_read_b64 v[90:91], v57 offset:8192
    ds_read_b64 v[92:93], v58 offset:8192
    ds_read_b64 v[94:95], v59 offset:8192
    s_waitcnt lgkmcnt(8)
    v_mfma_f32_32x32x16_bf16 v[128:143], v[72:75], v[16:19], 0
    v_mfma_f32_32x32x16_bf16 v[128:143], v[76:79], v[20:23], v[128:143]
    v_cndmask_b32 v96, v96, v224, s[40:41]
    v_cndmask_b32 v97, v97, v225, s[42:43]
    v_cndmask_b32 v98, v98, v226, s[44:45]
    v_cndmask_b32 v99, v99, v227, s[46:47]
    v_cndmask_b32 v100, v100, v228, s[48:49]
    v_cndmask_b32 v101, v101, v229, s[50:51]
    v_cndmask_b32 v102, v102, v230, s[52:53]
    v_cndmask_b32 v103, v103, v231, s[54:55]
    v_cndmask_b32 v104, v104, v232, s[56:57]
    v_cndmask_b32 v105, v105, v233, s[58:59]
    v_cndmask_b32 v106, v106, v234, s[60:61]
    v_cndmask_b32 v107, v107, v235, s[62:63]
    v_cndmask_b32 v108, v108, v236, s[64:65]
    v_cndmask_b32 v109, v109, v237, s[66:67]
    v_cndmask_b32 v110, v110, v238, s[68:69]
    v_cndmask_b32 v111, v111, v239, s[70:71]
    ds_read_b64 v[72:73], v56 offset:10240
    ds_read_b64 v[74:75], v57 offset:10240
    ds_read_b64 v[76:77], v58 offset:10240
    ds_read_b64 v[78:79], v59 offset:10240
    s_waitcnt lgkmcnt(8)
    v_mfma_f32_32x32x16_bf16 v[144:159], v[80:83], v[16:19], 0
    v_mfma_f32_32x32x16_bf16 v[144:159], v[84:87], v[20:23], v[144:159]
    v_max3_f32 v68, v96, v97, v98
    v_max_f32 v68, v68, v99
    v_max3_f32 v68, v68, v100, v101
    v_max3_f32 v68, v68, v102, v103
    v_max3_f32 v68, v68, v104, v105
    v_max3_f32 v68, v68, v106, v107
    v_max3_f32 v68, v68, v108, v109
    v_max3_f32 v68, v68, v110, v111
    v_max3_f32 v68, v68, v112, v113
    v_max3_f32 v68, v68, v114, v115
    v_max3_f32 v68, v68, v116, v117
    v_max3_f32 v68, v68, v118, v119
    v_max3_f32 v68, v68, v120, v121
    v_max3_f32 v68, v68, v122, v123
    v_max3_f32 v68, v68, v124, v125
    v_max3_f32 v68, v68, v126, v127
    ds_read_b64 v[80:81], v56 offset:12288
    ds_read_b64 v[82:83], v57 offset:12288
    ds_read_b64 v[84:85], v58 offset:12288
    ds_read_b64 v[86:87], v59 offset:12288
    s_waitcnt lgkmcnt(8)
    v_mfma_f32_32x32x16_bf16 v[160:175], v[88:91], v[16:19], 0
    v_mfma_f32_32x32x16_bf16 v[160:175], v[92:95], v[20:23], v[160:175]
    v_max3_f32 v68, v68, v128, v129
    v_max3_f32 v68, v68, v130, v131
    v_max3_f32 v68, v68, v132, v133
    v_max3_f32 v68, v68, v134, v135
    v_max3_f32 v68, v68, v136, v137
    v_max3_f32 v68, v68, v138, v139
    v_max3_f32 v68, v68, v140, v141
    v_max3_f32 v68, v68, v142, v143
    ds_read_b64 v[88:89], v56 offset:14336
    ds_read_b64 v[90:91], v57 offset:14336
    ds_read_b64 v[92:93], v58 offset:14336
    ds_read_b64 v[94:95], v59 offset:14336
    s_waitcnt lgkmcnt(8)
    v_mfma_f32_32x32x16_bf16 v[176:191], v[72:75], v[16:19], 0
    v_mfma_f32_32x32x16_bf16 v[176:191], v[76:79], v[20:23], v[176:191]
    v_max3_f32 v68, v68, v144, v145
    v_max3_f32 v68, v68, v146, v147
    v_max3_f32 v68, v68, v148, v149
    v_max3_f32 v68, v68, v150, v151
    v_max3_f32 v68, v68, v152, v153
    v_max3_f32 v68, v68, v154, v155
    v_max3_f32 v68, v68, v156, v157
    v_max3_f32 v68, v68, v158, v159
    s_waitcnt lgkmcnt(4)
    v_mfma_f32_32x32x16_bf16 v[192:207], v[80:83], v[16:19], 0
    v_mfma_f32_32x32x16_bf16 v[192:207], v[84:87], v[20:23], v[192:207]
    v_max3_f32 v68, v68, v160, v161
    v_max3_f32 v68, v68, v162, v163
    v_max3_f32 v68, v68, v164, v165
    v_max3_f32 v68, v68, v166, v167
    v_max3_f32 v68, v68, v168, v169
    v_max3_f32 v68, v68, v170, v171
    v_max3_f32 v68, v68, v172, v173
    v_max3_f32 v68, v68, v174, v175
    s_waitcnt lgkmcnt(0)
    v_mfma_f32_32x32x16_bf16 v[208:223], v[88:91], v[16:19], 0
    v_mfma_f32_32x32x16_bf16 v[208:223], v[92:95], v[20:23], v[208:223]
    v_max3_f32 v68, v68, v176, v177
    v_max3_f32 v68, v68, v178, v179
    v_max3_f32 v68, v68, v180, v181
    v_max3_f32 v68, v68, v182, v183
    v_max3_f32 v68, v68, v184, v185
    v_max3_f32 v68, v68, v186, v187
    v_max3_f32 v68, v68, v188, v189
    v_max3_f32 v68, v68, v190, v191
    s_waitcnt vmcnt(0)
    v_mov_b32 v13, 0
    ds_write_b64 v8, v[12:13] offset:34560
    v_max3_f32 v68, v68, v192, v193
    v_max3_f32 v68, v68, v194, v195
    v_max3_f32 v68, v68, v196, v197
    v_max3_f32 v68, v68, v198, v199
    v_max3_f32 v68, v68, v200, v201
    v_max3_f32 v68, v68, v202, v203
    v_max3_f32 v68, v68, v204, v205
    v_max3_f32 v68, v68, v206, v207
    s_waitcnt lgkmcnt(0)
    s_barrier
    v_max3_f32 v68, v68, v208, v209
    v_max3_f32 v68, v68, v210, v211
    v_max3_f32 v68, v68, v212, v213
    v_max3_f32 v68, v68, v214, v215
    v_max3_f32 v68, v68, v216, v217
    v_max3_f32 v68, v68, v218, v219
    v_max3_f32 v68, v68, v220, v221
    v_max3_f32 v68, v68, v222, v223
    s_cmp_eq_u32 s20, 0
    s_cselect_b32 s24, s4, s6
    s_cselect_b32 s25, s5, s7
    s_and_b32 s25, s25, 0xffff
    s_mov_b32 s26, 401408
    s_mov_b32 s27, 0x20000
    s_lshr_b32 s36, s2, 3
    s_lshl_b32 s36, s36, 3
    s_add_u32 s36, s36, s23
    s_mul_i32 s36, s36, 1664
    v_and_b32 v2, 15, v1
    v_lshlrev_b32 v2, 7, v2
    buffer_load_dword v48, v2, s[24:27], s36 offen
    ds_read_b64_tr_b16 v[72:73], v60 offset:32768
    ds_read_b64_tr_b16 v[74:75], v61 offset:32768
    ds_read_b64_tr_b16 v[76:77], v62 offset:32768
    ds_read_b64_tr_b16 v[78:79], v63 offset:32768
    ds_read_b64_tr_b16 v[80:81], v60 offset:34816
    ds_read_b64_tr_b16 v[82:83], v61 offset:34816
    ds_read_b64_tr_b16 v[84:85], v62 offset:34816
    ds_read_b64_tr_b16 v[86:87], v63 offset:34816
    v_mov_b32 v69, v68
    s_nop 1
    v_permlane32_swap_b32 v68, v69
    v_max_f32 v68, v68, v69
    v_cvt_pk_bf16_f32 v68, 0, v68
    v_mul_f32 v68, v70, v68
    v_cvt_pk_bf16_f32 v68, 0, v68
    v_mul_f32 v66, v64, v68
    v_xor_b32 v66, 0x80000000, v66
    v_mov_b32 v67, v66
    v_cvt_pk_bf16_f32 v96, 0, v96
    v_cvt_pk_bf16_f32 v97, 0, v97
    v_cvt_pk_bf16_f32 v98, 0, v98
    v_cvt_pk_bf16_f32 v99, 0, v99
    v_cvt_pk_bf16_f32 v100, 0, v100
    v_cvt_pk_bf16_f32 v101, 0, v101
    v_cvt_pk_bf16_f32 v102, 0, v102
    v_cvt_pk_bf16_f32 v103, 0, v103
    v_cvt_pk_bf16_f32 v104, 0, v104
    v_cvt_pk_bf16_f32 v105, 0, v105
    v_cvt_pk_bf16_f32 v106, 0, v106
    v_cvt_pk_bf16_f32 v107, 0, v107
    v_cvt_pk_bf16_f32 v108, 0, v108
    v_cvt_pk_bf16_f32 v109, 0, v109
    v_cvt_pk_bf16_f32 v110, 0, v110
    v_cvt_pk_bf16_f32 v111, 0, v111
    v_pk_mul_f32 v[96:97], v[96:97], v[70:71]
    v_pk_mul_f32 v[98:99], v[98:99], v[70:71]
    v_pk_mul_f32 v[100:101], v[100:101], v[70:71]
    v_pk_mul_f32 v[102:103], v[102:103], v[70:71]
    v_pk_mul_f32 v[104:105], v[104:105], v[70:71]
    v_pk_mul_f32 v[106:107], v[106:107], v[70:71]
    v_pk_mul_f32 v[108:109], v[108:109], v[70:71]
    v_pk_mul_f32 v[110:111], v[110:111], v[70:71]
    v_cvt_pk_bf16_f32 v96, 0, v96
    v_cvt_pk_bf16_f32 v97, 0, v97
    v_cvt_pk_bf16_f32 v98, 0, v98
    v_cvt_pk_bf16_f32 v99, 0, v99
    v_cvt_pk_bf16_f32 v100, 0, v100
    v_cvt_pk_bf16_f32 v101, 0, v101
    v_cvt_pk_bf16_f32 v102, 0, v102
    v_cvt_pk_bf16_f32 v103, 0, v103
    v_cvt_pk_bf16_f32 v104, 0, v104
    v_cvt_pk_bf16_f32 v105, 0, v105
    v_cvt_pk_bf16_f32 v106, 0, v106
    v_cvt_pk_bf16_f32 v107, 0, v107
    v_cvt_pk_bf16_f32 v108, 0, v108
    v_cvt_pk_bf16_f32 v109, 0, v109
    v_cvt_pk_bf16_f32 v110, 0, v110
    v_cvt_pk_bf16_f32 v111, 0, v111
    v_pk_fma_f32 v[96:97], v[96:97], v[64:65], v[66:67]
    v_pk_fma_f32 v[98:99], v[98:99], v[64:65], v[66:67]
    v_pk_fma_f32 v[100:101], v[100:101], v[64:65], v[66:67]
    v_pk_fma_f32 v[102:103], v[102:103], v[64:65], v[66:67]
    v_pk_fma_f32 v[104:105], v[104:105], v[64:65], v[66:67]
    v_pk_fma_f32 v[106:107], v[106:107], v[64:65], v[66:67]
    v_pk_fma_f32 v[108:109], v[108:109], v[64:65], v[66:67]
    v_pk_fma_f32 v[110:111], v[110:111], v[64:65], v[66:67]
    v_exp_f32 v96, v96
    v_exp_f32 v97, v97
    v_exp_f32 v98, v98
    v_exp_f32 v99, v99
    v_exp_f32 v100, v100
    v_exp_f32 v101, v101
    v_exp_f32 v102, v102
    v_exp_f32 v103, v103
    v_exp_f32 v104, v104
    v_exp_f32 v105, v105
    v_exp_f32 v106, v106
    v_exp_f32 v107, v107
    v_exp_f32 v108, v108
    v_exp_f32 v109, v109
    v_exp_f32 v110, v110
    v_exp_f32 v111, v111
    v_cndmask_b32 v224, 0, v96, s[40:41]
    v_cndmask_b32 v225, 0, v97, s[42:43]
    v_cndmask_b32 v226, 0, v98, s[44:45]
    v_cndmask_b32 v227, 0, v99, s[46:47]
    v_cndmask_b32 v228, 0, v100, s[48:49]
    v_cndmask_b32 v229, 0, v101, s[50:51]
    v_cndmask_b32 v230, 0, v102, s[52:53]
    v_cndmask_b32 v231, 0, v103, s[54:55]
    v_cndmask_b32 v232, 0, v104, s[56:57]
    v_cndmask_b32 v233, 0, v105, s[58:59]
    v_cndmask_b32 v234, 0, v106, s[60:61]
    v_cndmask_b32 v235, 0, v107, s[62:63]
    v_cndmask_b32 v236, 0, v108, s[64:65]
    v_cndmask_b32 v237, 0, v109, s[66:67]
    v_cndmask_b32 v238, 0, v110, s[68:69]
    v_cndmask_b32 v239, 0, v111, s[70:71]
    v_sub_f32 v96, v96, v224
    v_sub_f32 v97, v97, v225
    v_sub_f32 v98, v98, v226
    v_sub_f32 v99, v99, v227
    v_sub_f32 v100, v100, v228
    v_sub_f32 v101, v101, v229
    v_sub_f32 v102, v102, v230
    v_sub_f32 v103, v103, v231
    v_sub_f32 v104, v104, v232
    v_sub_f32 v105, v105, v233
    v_sub_f32 v106, v106, v234
    v_sub_f32 v107, v107, v235
    v_sub_f32 v108, v108, v236
    v_sub_f32 v109, v109, v237
    v_sub_f32 v110, v110, v238
    v_sub_f32 v111, v111, v239
    v_cvt_pk_bf16_f32 v96, v96, v97
    v_cvt_pk_bf16_f32 v97, v98, v99
    v_cvt_pk_bf16_f32 v98, v100, v101
    v_cvt_pk_bf16_f32 v99, v102, v103
    v_cvt_pk_bf16_f32 v100, v104, v105
    v_cvt_pk_bf16_f32 v101, v106, v107
    v_cvt_pk_bf16_f32 v102, v108, v109
    v_cvt_pk_bf16_f32 v103, v110, v111
    v_cvt_pk_bf16_f32 v224, v224, v225
    v_cvt_pk_bf16_f32 v225, v226, v227
    v_cvt_pk_bf16_f32 v226, v228, v229
    v_cvt_pk_bf16_f32 v227, v230, v231
    v_cvt_pk_bf16_f32 v228, v232, v233
    v_cvt_pk_bf16_f32 v229, v234, v235
    v_cvt_pk_bf16_f32 v230, v236, v237
    v_cvt_pk_bf16_f32 v231, v238, v239
    ds_read_b64_tr_b16 v[88:89], v60 offset:36864
    ds_read_b64_tr_b16 v[90:91], v61 offset:36864
    ds_read_b64_tr_b16 v[92:93], v62 offset:36864
    ds_read_b64_tr_b16 v[94:95], v63 offset:36864
    s_waitcnt lgkmcnt(8)
    v_mfma_f32_32x32x16_bf16 v[24:39], v[72:75], v[96:99], 0
    v_mfma_f32_32x32x16_bf16 v[24:39], v[76:79], v[100:103], v[24:39]
    v_cvt_pk_bf16_f32 v112, 0, v112
    v_cvt_pk_bf16_f32 v113, 0, v113
    v_cvt_pk_bf16_f32 v114, 0, v114
    v_cvt_pk_bf16_f32 v115, 0, v115
    v_cvt_pk_bf16_f32 v116, 0, v116
    v_cvt_pk_bf16_f32 v117, 0, v117
    v_cvt_pk_bf16_f32 v118, 0, v118
    v_cvt_pk_bf16_f32 v119, 0, v119
    v_cvt_pk_bf16_f32 v120, 0, v120
    v_cvt_pk_bf16_f32 v121, 0, v121
    v_cvt_pk_bf16_f32 v122, 0, v122
    v_cvt_pk_bf16_f32 v123, 0, v123
    v_cvt_pk_bf16_f32 v124, 0, v124
    v_cvt_pk_bf16_f32 v125, 0, v125
    v_cvt_pk_bf16_f32 v126, 0, v126
    v_cvt_pk_bf16_f32 v127, 0, v127
    v_pk_mul_f32 v[112:113], v[112:113], v[70:71]
    v_pk_mul_f32 v[114:115], v[114:115], v[70:71]
    v_pk_mul_f32 v[116:117], v[116:117], v[70:71]
    v_pk_mul_f32 v[118:119], v[118:119], v[70:71]
    v_pk_mul_f32 v[120:121], v[120:121], v[70:71]
    v_pk_mul_f32 v[122:123], v[122:123], v[70:71]
    v_pk_mul_f32 v[124:125], v[124:125], v[70:71]
    v_pk_mul_f32 v[126:127], v[126:127], v[70:71]
    v_cvt_pk_bf16_f32 v112, 0, v112
    v_cvt_pk_bf16_f32 v113, 0, v113
    v_cvt_pk_bf16_f32 v114, 0, v114
    v_cvt_pk_bf16_f32 v115, 0, v115
    v_cvt_pk_bf16_f32 v116, 0, v116
    v_cvt_pk_bf16_f32 v117, 0, v117
    v_cvt_pk_bf16_f32 v118, 0, v118
    v_cvt_pk_bf16_f32 v119, 0, v119
    v_cvt_pk_bf16_f32 v120, 0, v120
    v_cvt_pk_bf16_f32 v121, 0, v121
    v_cvt_pk_bf16_f32 v122, 0, v122
    v_cvt_pk_bf16_f32 v123, 0, v123
    v_cvt_pk_bf16_f32 v124, 0, v124
    v_cvt_pk_bf16_f32 v125, 0, v125
    v_cvt_pk_bf16_f32 v126, 0, v126
    v_cvt_pk_bf16_f32 v127, 0, v127
    v_pk_fma_f32 v[112:113], v[112:113], v[64:65], v[66:67]
    v_pk_fma_f32 v[114:115], v[114:115], v[64:65], v[66:67]
    v_pk_fma_f32 v[116:117], v[116:117], v[64:65], v[66:67]
    v_pk_fma_f32 v[118:119], v[118:119], v[64:65], v[66:67]
    v_pk_fma_f32 v[120:121], v[120:121], v[64:65], v[66:67]
    v_pk_fma_f32 v[122:123], v[122:123], v[64:65], v[66:67]
    v_pk_fma_f32 v[124:125], v[124:125], v[64:65], v[66:67]
    v_pk_fma_f32 v[126:127], v[126:127], v[64:65], v[66:67]
    v_exp_f32 v112, v112
    v_exp_f32 v113, v113
    v_exp_f32 v114, v114
    v_exp_f32 v115, v115
    v_exp_f32 v116, v116
    v_exp_f32 v117, v117
    v_exp_f32 v118, v118
    v_exp_f32 v119, v119
    v_exp_f32 v120, v120
    v_exp_f32 v121, v121
    v_exp_f32 v122, v122
    v_exp_f32 v123, v123
    v_exp_f32 v124, v124
    v_exp_f32 v125, v125
    v_exp_f32 v126, v126
    v_exp_f32 v127, v127
    v_cvt_pk_bf16_f32 v112, v112, v113
    v_cvt_pk_bf16_f32 v113, v114, v115
    v_cvt_pk_bf16_f32 v114, v116, v117
    v_cvt_pk_bf16_f32 v115, v118, v119
    v_cvt_pk_bf16_f32 v116, v120, v121
    v_cvt_pk_bf16_f32 v117, v122, v123
    v_cvt_pk_bf16_f32 v118, v124, v125
    v_cvt_pk_bf16_f32 v119, v126, v127
    ds_read_b64_tr_b16 v[72:73], v60 offset:38912
    ds_read_b64_tr_b16 v[74:75], v61 offset:38912
    ds_read_b64_tr_b16 v[76:77], v62 offset:38912
    ds_read_b64_tr_b16 v[78:79], v63 offset:38912
    s_waitcnt lgkmcnt(8)
    v_mfma_f32_32x32x16_bf16 v[24:39], v[80:83], v[112:115], v[24:39]
    v_mfma_f32_32x32x16_bf16 v[24:39], v[84:87], v[116:119], v[24:39]
    v_cvt_pk_bf16_f32 v128, 0, v128
    v_cvt_pk_bf16_f32 v129, 0, v129
    v_cvt_pk_bf16_f32 v130, 0, v130
    v_cvt_pk_bf16_f32 v131, 0, v131
    v_cvt_pk_bf16_f32 v132, 0, v132
    v_cvt_pk_bf16_f32 v133, 0, v133
    v_cvt_pk_bf16_f32 v134, 0, v134
    v_cvt_pk_bf16_f32 v135, 0, v135
    v_cvt_pk_bf16_f32 v136, 0, v136
    v_cvt_pk_bf16_f32 v137, 0, v137
    v_cvt_pk_bf16_f32 v138, 0, v138
    v_cvt_pk_bf16_f32 v139, 0, v139
    v_cvt_pk_bf16_f32 v140, 0, v140
    v_cvt_pk_bf16_f32 v141, 0, v141
    v_cvt_pk_bf16_f32 v142, 0, v142
    v_cvt_pk_bf16_f32 v143, 0, v143
    v_pk_mul_f32 v[128:129], v[128:129], v[70:71]
    v_pk_mul_f32 v[130:131], v[130:131], v[70:71]
    v_pk_mul_f32 v[132:133], v[132:133], v[70:71]
    v_pk_mul_f32 v[134:135], v[134:135], v[70:71]
    v_pk_mul_f32 v[136:137], v[136:137], v[70:71]
    v_pk_mul_f32 v[138:139], v[138:139], v[70:71]
    v_pk_mul_f32 v[140:141], v[140:141], v[70:71]
    v_pk_mul_f32 v[142:143], v[142:143], v[70:71]
    v_cvt_pk_bf16_f32 v128, 0, v128
    v_cvt_pk_bf16_f32 v129, 0, v129
    v_cvt_pk_bf16_f32 v130, 0, v130
    v_cvt_pk_bf16_f32 v131, 0, v131
    v_cvt_pk_bf16_f32 v132, 0, v132
    v_cvt_pk_bf16_f32 v133, 0, v133
    v_cvt_pk_bf16_f32 v134, 0, v134
    v_cvt_pk_bf16_f32 v135, 0, v135
    v_cvt_pk_bf16_f32 v136, 0, v136
    v_cvt_pk_bf16_f32 v137, 0, v137
    v_cvt_pk_bf16_f32 v138, 0, v138
    v_cvt_pk_bf16_f32 v139, 0, v139
    v_cvt_pk_bf16_f32 v140, 0, v140
    v_cvt_pk_bf16_f32 v141, 0, v141
    v_cvt_pk_bf16_f32 v142, 0, v142
    v_cvt_pk_bf16_f32 v143, 0, v143
    v_pk_fma_f32 v[128:129], v[128:129], v[64:65], v[66:67]
    v_pk_fma_f32 v[130:131], v[130:131], v[64:65], v[66:67]
    v_pk_fma_f32 v[132:133], v[132:133], v[64:65], v[66:67]
    v_pk_fma_f32 v[134:135], v[134:135], v[64:65], v[66:67]
    v_pk_fma_f32 v[136:137], v[136:137], v[64:65], v[66:67]
    v_pk_fma_f32 v[138:139], v[138:139], v[64:65], v[66:67]
    v_pk_fma_f32 v[140:141], v[140:141], v[64:65], v[66:67]
    v_pk_fma_f32 v[142:143], v[142:143], v[64:65], v[66:67]
    v_exp_f32 v128, v128
    v_exp_f32 v129, v129
    v_exp_f32 v130, v130
    v_exp_f32 v131, v131
    v_exp_f32 v132, v132
    v_exp_f32 v133, v133
    v_exp_f32 v134, v134
    v_exp_f32 v135, v135
    v_exp_f32 v136, v136
    v_exp_f32 v137, v137
    v_exp_f32 v138, v138
    v_exp_f32 v139, v139
    v_exp_f32 v140, v140
    v_exp_f32 v141, v141
    v_exp_f32 v142, v142
    v_exp_f32 v143, v143
    v_cvt_pk_bf16_f32 v128, v128, v129
    v_cvt_pk_bf16_f32 v129, v130, v131
    v_cvt_pk_bf16_f32 v130, v132, v133
    v_cvt_pk_bf16_f32 v131, v134, v135
    v_cvt_pk_bf16_f32 v132, v136, v137
    v_cvt_pk_bf16_f32 v133, v138, v139
    v_cvt_pk_bf16_f32 v134, v140, v141
    v_cvt_pk_bf16_f32 v135, v142, v143
    ds_read_b64_tr_b16 v[80:81], v60 offset:40960
    ds_read_b64_tr_b16 v[82:83], v61 offset:40960
    ds_read_b64_tr_b16 v[84:85], v62 offset:40960
    ds_read_b64_tr_b16 v[86:87], v63 offset:40960
    s_waitcnt lgkmcnt(8)
    v_mfma_f32_32x32x16_bf16 v[24:39], v[88:91], v[128:131], v[24:39]
    v_mfma_f32_32x32x16_bf16 v[24:39], v[92:95], v[132:135], v[24:39]
    v_cvt_pk_bf16_f32 v144, 0, v144
    v_cvt_pk_bf16_f32 v145, 0, v145
    v_cvt_pk_bf16_f32 v146, 0, v146
    v_cvt_pk_bf16_f32 v147, 0, v147
    v_cvt_pk_bf16_f32 v148, 0, v148
    v_cvt_pk_bf16_f32 v149, 0, v149
    v_cvt_pk_bf16_f32 v150, 0, v150
    v_cvt_pk_bf16_f32 v151, 0, v151
    v_cvt_pk_bf16_f32 v152, 0, v152
    v_cvt_pk_bf16_f32 v153, 0, v153
    v_cvt_pk_bf16_f32 v154, 0, v154
    v_cvt_pk_bf16_f32 v155, 0, v155
    v_cvt_pk_bf16_f32 v156, 0, v156
    v_cvt_pk_bf16_f32 v157, 0, v157
    v_cvt_pk_bf16_f32 v158, 0, v158
    v_cvt_pk_bf16_f32 v159, 0, v159
    v_pk_mul_f32 v[144:145], v[144:145], v[70:71]
    v_pk_mul_f32 v[146:147], v[146:147], v[70:71]
    v_pk_mul_f32 v[148:149], v[148:149], v[70:71]
    v_pk_mul_f32 v[150:151], v[150:151], v[70:71]
    v_pk_mul_f32 v[152:153], v[152:153], v[70:71]
    v_pk_mul_f32 v[154:155], v[154:155], v[70:71]
    v_pk_mul_f32 v[156:157], v[156:157], v[70:71]
    v_pk_mul_f32 v[158:159], v[158:159], v[70:71]
    v_cvt_pk_bf16_f32 v144, 0, v144
    v_cvt_pk_bf16_f32 v145, 0, v145
    v_cvt_pk_bf16_f32 v146, 0, v146
    v_cvt_pk_bf16_f32 v147, 0, v147
    v_cvt_pk_bf16_f32 v148, 0, v148
    v_cvt_pk_bf16_f32 v149, 0, v149
    v_cvt_pk_bf16_f32 v150, 0, v150
    v_cvt_pk_bf16_f32 v151, 0, v151
    v_cvt_pk_bf16_f32 v152, 0, v152
    v_cvt_pk_bf16_f32 v153, 0, v153
    v_cvt_pk_bf16_f32 v154, 0, v154
    v_cvt_pk_bf16_f32 v155, 0, v155
    v_cvt_pk_bf16_f32 v156, 0, v156
    v_cvt_pk_bf16_f32 v157, 0, v157
    v_cvt_pk_bf16_f32 v158, 0, v158
    v_cvt_pk_bf16_f32 v159, 0, v159
    v_pk_fma_f32 v[144:145], v[144:145], v[64:65], v[66:67]
    v_pk_fma_f32 v[146:147], v[146:147], v[64:65], v[66:67]
    v_pk_fma_f32 v[148:149], v[148:149], v[64:65], v[66:67]
    v_pk_fma_f32 v[150:151], v[150:151], v[64:65], v[66:67]
    v_pk_fma_f32 v[152:153], v[152:153], v[64:65], v[66:67]
    v_pk_fma_f32 v[154:155], v[154:155], v[64:65], v[66:67]
    v_pk_fma_f32 v[156:157], v[156:157], v[64:65], v[66:67]
    v_pk_fma_f32 v[158:159], v[158:159], v[64:65], v[66:67]
    v_exp_f32 v144, v144
    v_exp_f32 v145, v145
    v_exp_f32 v146, v146
    v_exp_f32 v147, v147
    v_exp_f32 v148, v148
    v_exp_f32 v149, v149
    v_exp_f32 v150, v150
    v_exp_f32 v151, v151
    v_exp_f32 v152, v152
    v_exp_f32 v153, v153
    v_exp_f32 v154, v154
    v_exp_f32 v155, v155
    v_exp_f32 v156, v156
    v_exp_f32 v157, v157
    v_exp_f32 v158, v158
    v_exp_f32 v159, v159
    v_cvt_pk_bf16_f32 v144, v144, v145
    v_cvt_pk_bf16_f32 v145, v146, v147
    v_cvt_pk_bf16_f32 v146, v148, v149
    v_cvt_pk_bf16_f32 v147, v150, v151
    v_cvt_pk_bf16_f32 v148, v152, v153
    v_cvt_pk_bf16_f32 v149, v154, v155
    v_cvt_pk_bf16_f32 v150, v156, v157
    v_cvt_pk_bf16_f32 v151, v158, v159
    ds_read_b64_tr_b16 v[88:89], v60 offset:43008
    ds_read_b64_tr_b16 v[90:91], v61 offset:43008
    ds_read_b64_tr_b16 v[92:93], v62 offset:43008
    ds_read_b64_tr_b16 v[94:95], v63 offset:43008
    s_waitcnt lgkmcnt(8)
    v_mfma_f32_32x32x16_bf16 v[24:39], v[72:75], v[144:147], v[24:39]
    v_mfma_f32_32x32x16_bf16 v[24:39], v[76:79], v[148:151], v[24:39]
    v_cvt_pk_bf16_f32 v160, 0, v160
    v_cvt_pk_bf16_f32 v161, 0, v161
    v_cvt_pk_bf16_f32 v162, 0, v162
    v_cvt_pk_bf16_f32 v163, 0, v163
    v_cvt_pk_bf16_f32 v164, 0, v164
    v_cvt_pk_bf16_f32 v165, 0, v165
    v_cvt_pk_bf16_f32 v166, 0, v166
    v_cvt_pk_bf16_f32 v167, 0, v167
    v_cvt_pk_bf16_f32 v168, 0, v168
    v_cvt_pk_bf16_f32 v169, 0, v169
    v_cvt_pk_bf16_f32 v170, 0, v170
    v_cvt_pk_bf16_f32 v171, 0, v171
    v_cvt_pk_bf16_f32 v172, 0, v172
    v_cvt_pk_bf16_f32 v173, 0, v173
    v_cvt_pk_bf16_f32 v174, 0, v174
    v_cvt_pk_bf16_f32 v175, 0, v175
    v_pk_mul_f32 v[160:161], v[160:161], v[70:71]
    v_pk_mul_f32 v[162:163], v[162:163], v[70:71]
    v_pk_mul_f32 v[164:165], v[164:165], v[70:71]
    v_pk_mul_f32 v[166:167], v[166:167], v[70:71]
    v_pk_mul_f32 v[168:169], v[168:169], v[70:71]
    v_pk_mul_f32 v[170:171], v[170:171], v[70:71]
    v_pk_mul_f32 v[172:173], v[172:173], v[70:71]
    v_pk_mul_f32 v[174:175], v[174:175], v[70:71]
    v_cvt_pk_bf16_f32 v160, 0, v160
    v_cvt_pk_bf16_f32 v161, 0, v161
    v_cvt_pk_bf16_f32 v162, 0, v162
    v_cvt_pk_bf16_f32 v163, 0, v163
    v_cvt_pk_bf16_f32 v164, 0, v164
    v_cvt_pk_bf16_f32 v165, 0, v165
    v_cvt_pk_bf16_f32 v166, 0, v166
    v_cvt_pk_bf16_f32 v167, 0, v167
    v_cvt_pk_bf16_f32 v168, 0, v168
    v_cvt_pk_bf16_f32 v169, 0, v169
    v_cvt_pk_bf16_f32 v170, 0, v170
    v_cvt_pk_bf16_f32 v171, 0, v171
    v_cvt_pk_bf16_f32 v172, 0, v172
    v_cvt_pk_bf16_f32 v173, 0, v173
    v_cvt_pk_bf16_f32 v174, 0, v174
    v_cvt_pk_bf16_f32 v175, 0, v175
    v_pk_fma_f32 v[160:161], v[160:161], v[64:65], v[66:67]
    v_pk_fma_f32 v[162:163], v[162:163], v[64:65], v[66:67]
    v_pk_fma_f32 v[164:165], v[164:165], v[64:65], v[66:67]
    v_pk_fma_f32 v[166:167], v[166:167], v[64:65], v[66:67]
    v_pk_fma_f32 v[168:169], v[168:169], v[64:65], v[66:67]
    v_pk_fma_f32 v[170:171], v[170:171], v[64:65], v[66:67]
    v_pk_fma_f32 v[172:173], v[172:173], v[64:65], v[66:67]
    v_pk_fma_f32 v[174:175], v[174:175], v[64:65], v[66:67]
    v_exp_f32 v160, v160
    v_exp_f32 v161, v161
    v_exp_f32 v162, v162
    v_exp_f32 v163, v163
    v_exp_f32 v164, v164
    v_exp_f32 v165, v165
    v_exp_f32 v166, v166
    v_exp_f32 v167, v167
    v_exp_f32 v168, v168
    v_exp_f32 v169, v169
    v_exp_f32 v170, v170
    v_exp_f32 v171, v171
    v_exp_f32 v172, v172
    v_exp_f32 v173, v173
    v_exp_f32 v174, v174
    v_exp_f32 v175, v175
    v_cvt_pk_bf16_f32 v160, v160, v161
    v_cvt_pk_bf16_f32 v161, v162, v163
    v_cvt_pk_bf16_f32 v162, v164, v165
    v_cvt_pk_bf16_f32 v163, v166, v167
    v_cvt_pk_bf16_f32 v164, v168, v169
    v_cvt_pk_bf16_f32 v165, v170, v171
    v_cvt_pk_bf16_f32 v166, v172, v173
    v_cvt_pk_bf16_f32 v167, v174, v175
    ds_read_b64_tr_b16 v[72:73], v60 offset:45056
    ds_read_b64_tr_b16 v[74:75], v61 offset:45056
    ds_read_b64_tr_b16 v[76:77], v62 offset:45056
    ds_read_b64_tr_b16 v[78:79], v63 offset:45056
    s_waitcnt lgkmcnt(8)
    v_mfma_f32_32x32x16_bf16 v[24:39], v[80:83], v[160:163], v[24:39]
    v_mfma_f32_32x32x16_bf16 v[24:39], v[84:87], v[164:167], v[24:39]
    v_cvt_pk_bf16_f32 v176, 0, v176
    v_cvt_pk_bf16_f32 v177, 0, v177
    v_cvt_pk_bf16_f32 v178, 0, v178
    v_cvt_pk_bf16_f32 v179, 0, v179
    v_cvt_pk_bf16_f32 v180, 0, v180
    v_cvt_pk_bf16_f32 v181, 0, v181
    v_cvt_pk_bf16_f32 v182, 0, v182
    v_cvt_pk_bf16_f32 v183, 0, v183
    v_cvt_pk_bf16_f32 v184, 0, v184
    v_cvt_pk_bf16_f32 v185, 0, v185
    v_cvt_pk_bf16_f32 v186, 0, v186
    v_cvt_pk_bf16_f32 v187, 0, v187
    v_cvt_pk_bf16_f32 v188, 0, v188
    v_cvt_pk_bf16_f32 v189, 0, v189
    v_cvt_pk_bf16_f32 v190, 0, v190
    v_cvt_pk_bf16_f32 v191, 0, v191
    v_pk_mul_f32 v[176:177], v[176:177], v[70:71]
    v_pk_mul_f32 v[178:179], v[178:179], v[70:71]
    v_pk_mul_f32 v[180:181], v[180:181], v[70:71]
    v_pk_mul_f32 v[182:183], v[182:183], v[70:71]
    v_pk_mul_f32 v[184:185], v[184:185], v[70:71]
    v_pk_mul_f32 v[186:187], v[186:187], v[70:71]
    v_pk_mul_f32 v[188:189], v[188:189], v[70:71]
    v_pk_mul_f32 v[190:191], v[190:191], v[70:71]
    v_cvt_pk_bf16_f32 v176, 0, v176
    v_cvt_pk_bf16_f32 v177, 0, v177
    v_cvt_pk_bf16_f32 v178, 0, v178
    v_cvt_pk_bf16_f32 v179, 0, v179
    v_cvt_pk_bf16_f32 v180, 0, v180
    v_cvt_pk_bf16_f32 v181, 0, v181
    v_cvt_pk_bf16_f32 v182, 0, v182
    v_cvt_pk_bf16_f32 v183, 0, v183
    v_cvt_pk_bf16_f32 v184, 0, v184
    v_cvt_pk_bf16_f32 v185, 0, v185
    v_cvt_pk_bf16_f32 v186, 0, v186
    v_cvt_pk_bf16_f32 v187, 0, v187
    v_cvt_pk_bf16_f32 v188, 0, v188
    v_cvt_pk_bf16_f32 v189, 0, v189
    v_cvt_pk_bf16_f32 v190, 0, v190
    v_cvt_pk_bf16_f32 v191, 0, v191
    v_pk_fma_f32 v[176:177], v[176:177], v[64:65], v[66:67]
    v_pk_fma_f32 v[178:179], v[178:179], v[64:65], v[66:67]
    v_pk_fma_f32 v[180:181], v[180:181], v[64:65], v[66:67]
    v_pk_fma_f32 v[182:183], v[182:183], v[64:65], v[66:67]
    v_pk_fma_f32 v[184:185], v[184:185], v[64:65], v[66:67]
    v_pk_fma_f32 v[186:187], v[186:187], v[64:65], v[66:67]
    v_pk_fma_f32 v[188:189], v[188:189], v[64:65], v[66:67]
    v_pk_fma_f32 v[190:191], v[190:191], v[64:65], v[66:67]
    v_exp_f32 v176, v176
    v_exp_f32 v177, v177
    v_exp_f32 v178, v178
    v_exp_f32 v179, v179
    v_exp_f32 v180, v180
    v_exp_f32 v181, v181
    v_exp_f32 v182, v182
    v_exp_f32 v183, v183
    v_exp_f32 v184, v184
    v_exp_f32 v185, v185
    v_exp_f32 v186, v186
    v_exp_f32 v187, v187
    v_exp_f32 v188, v188
    v_exp_f32 v189, v189
    v_exp_f32 v190, v190
    v_exp_f32 v191, v191
    v_cvt_pk_bf16_f32 v176, v176, v177
    v_cvt_pk_bf16_f32 v177, v178, v179
    v_cvt_pk_bf16_f32 v178, v180, v181
    v_cvt_pk_bf16_f32 v179, v182, v183
    v_cvt_pk_bf16_f32 v180, v184, v185
    v_cvt_pk_bf16_f32 v181, v186, v187
    v_cvt_pk_bf16_f32 v182, v188, v189
    v_cvt_pk_bf16_f32 v183, v190, v191
    ds_read_b64_tr_b16 v[80:81], v60 offset:47104
    ds_read_b64_tr_b16 v[82:83], v61 offset:47104
    ds_read_b64_tr_b16 v[84:85], v62 offset:47104
    ds_read_b64_tr_b16 v[86:87], v63 offset:47104
    s_waitcnt lgkmcnt(8)
    v_mfma_f32_32x32x16_bf16 v[24:39], v[88:91], v[176:179], v[24:39]
    v_mfma_f32_32x32x16_bf16 v[24:39], v[92:95], v[180:183], v[24:39]
    v_cvt_pk_bf16_f32 v192, 0, v192
    v_cvt_pk_bf16_f32 v193, 0, v193
    v_cvt_pk_bf16_f32 v194, 0, v194
    v_cvt_pk_bf16_f32 v195, 0, v195
    v_cvt_pk_bf16_f32 v196, 0, v196
    v_cvt_pk_bf16_f32 v197, 0, v197
    v_cvt_pk_bf16_f32 v198, 0, v198
    v_cvt_pk_bf16_f32 v199, 0, v199
    v_cvt_pk_bf16_f32 v200, 0, v200
    v_cvt_pk_bf16_f32 v201, 0, v201
    v_cvt_pk_bf16_f32 v202, 0, v202
    v_cvt_pk_bf16_f32 v203, 0, v203
    v_cvt_pk_bf16_f32 v204, 0, v204
    v_cvt_pk_bf16_f32 v205, 0, v205
    v_cvt_pk_bf16_f32 v206, 0, v206
    v_cvt_pk_bf16_f32 v207, 0, v207
    v_pk_mul_f32 v[192:193], v[192:193], v[70:71]
    v_pk_mul_f32 v[194:195], v[194:195], v[70:71]
    v_pk_mul_f32 v[196:197], v[196:197], v[70:71]
    v_pk_mul_f32 v[198:199], v[198:199], v[70:71]
    v_pk_mul_f32 v[200:201], v[200:201], v[70:71]
    v_pk_mul_f32 v[202:203], v[202:203], v[70:71]
    v_pk_mul_f32 v[204:205], v[204:205], v[70:71]
    v_pk_mul_f32 v[206:207], v[206:207], v[70:71]
    v_cvt_pk_bf16_f32 v192, 0, v192
    v_cvt_pk_bf16_f32 v193, 0, v193
    v_cvt_pk_bf16_f32 v194, 0, v194
    v_cvt_pk_bf16_f32 v195, 0, v195
    v_cvt_pk_bf16_f32 v196, 0, v196
    v_cvt_pk_bf16_f32 v197, 0, v197
    v_cvt_pk_bf16_f32 v198, 0, v198
    v_cvt_pk_bf16_f32 v199, 0, v199
    v_cvt_pk_bf16_f32 v200, 0, v200
    v_cvt_pk_bf16_f32 v201, 0, v201
    v_cvt_pk_bf16_f32 v202, 0, v202
    v_cvt_pk_bf16_f32 v203, 0, v203
    v_cvt_pk_bf16_f32 v204, 0, v204
    v_cvt_pk_bf16_f32 v205, 0, v205
    v_cvt_pk_bf16_f32 v206, 0, v206
    v_cvt_pk_bf16_f32 v207, 0, v207
    v_pk_fma_f32 v[192:193], v[192:193], v[64:65], v[66:67]
    v_pk_fma_f32 v[194:195], v[194:195], v[64:65], v[66:67]
    v_pk_fma_f32 v[196:197], v[196:197], v[64:65], v[66:67]
    v_pk_fma_f32 v[198:199], v[198:199], v[64:65], v[66:67]
    v_pk_fma_f32 v[200:201], v[200:201], v[64:65], v[66:67]
    v_pk_fma_f32 v[202:203], v[202:203], v[64:65], v[66:67]
    v_pk_fma_f32 v[204:205], v[204:205], v[64:65], v[66:67]
    v_pk_fma_f32 v[206:207], v[206:207], v[64:65], v[66:67]
    v_exp_f32 v192, v192
    v_exp_f32 v193, v193
    v_exp_f32 v194, v194
    v_exp_f32 v195, v195
    v_exp_f32 v196, v196
    v_exp_f32 v197, v197
    v_exp_f32 v198, v198
    v_exp_f32 v199, v199
    v_exp_f32 v200, v200
    v_exp_f32 v201, v201
    v_exp_f32 v202, v202
    v_exp_f32 v203, v203
    v_exp_f32 v204, v204
    v_exp_f32 v205, v205
    v_exp_f32 v206, v206
    v_exp_f32 v207, v207
    v_cvt_pk_bf16_f32 v192, v192, v193
    v_cvt_pk_bf16_f32 v193, v194, v195
    v_cvt_pk_bf16_f32 v194, v196, v197
    v_cvt_pk_bf16_f32 v195, v198, v199
    v_cvt_pk_bf16_f32 v196, v200, v201
    v_cvt_pk_bf16_f32 v197, v202, v203
    v_cvt_pk_bf16_f32 v198, v204, v205
    v_cvt_pk_bf16_f32 v199, v206, v207
    ds_read_b64_tr_b16 v[88:89], v60 offset:49152
    ds_read_b64_tr_b16 v[90:91], v61 offset:49152
    ds_read_b64_tr_b16 v[92:93], v62 offset:49152
    ds_read_b64_tr_b16 v[94:95], v63 offset:49152
    s_waitcnt lgkmcnt(8)
    v_mfma_f32_32x32x16_bf16 v[24:39], v[72:75], v[192:195], v[24:39]
    v_mfma_f32_32x32x16_bf16 v[24:39], v[76:79], v[196:199], v[24:39]
    v_cvt_pk_bf16_f32 v208, 0, v208
    v_cvt_pk_bf16_f32 v209, 0, v209
    v_cvt_pk_bf16_f32 v210, 0, v210
    v_cvt_pk_bf16_f32 v211, 0, v211
    v_cvt_pk_bf16_f32 v212, 0, v212
    v_cvt_pk_bf16_f32 v213, 0, v213
    v_cvt_pk_bf16_f32 v214, 0, v214
    v_cvt_pk_bf16_f32 v215, 0, v215
    v_cvt_pk_bf16_f32 v216, 0, v216
    v_cvt_pk_bf16_f32 v217, 0, v217
    v_cvt_pk_bf16_f32 v218, 0, v218
    v_cvt_pk_bf16_f32 v219, 0, v219
    v_cvt_pk_bf16_f32 v220, 0, v220
    v_cvt_pk_bf16_f32 v221, 0, v221
    v_cvt_pk_bf16_f32 v222, 0, v222
    v_cvt_pk_bf16_f32 v223, 0, v223
    v_pk_mul_f32 v[208:209], v[208:209], v[70:71]
    v_pk_mul_f32 v[210:211], v[210:211], v[70:71]
    v_pk_mul_f32 v[212:213], v[212:213], v[70:71]
    v_pk_mul_f32 v[214:215], v[214:215], v[70:71]
    v_pk_mul_f32 v[216:217], v[216:217], v[70:71]
    v_pk_mul_f32 v[218:219], v[218:219], v[70:71]
    v_pk_mul_f32 v[220:221], v[220:221], v[70:71]
    v_pk_mul_f32 v[222:223], v[222:223], v[70:71]
    v_cvt_pk_bf16_f32 v208, 0, v208
    v_cvt_pk_bf16_f32 v209, 0, v209
    v_cvt_pk_bf16_f32 v210, 0, v210
    v_cvt_pk_bf16_f32 v211, 0, v211
    v_cvt_pk_bf16_f32 v212, 0, v212
    v_cvt_pk_bf16_f32 v213, 0, v213
    v_cvt_pk_bf16_f32 v214, 0, v214
    v_cvt_pk_bf16_f32 v215, 0, v215
    v_cvt_pk_bf16_f32 v216, 0, v216
    v_cvt_pk_bf16_f32 v217, 0, v217
    v_cvt_pk_bf16_f32 v218, 0, v218
    v_cvt_pk_bf16_f32 v219, 0, v219
    v_cvt_pk_bf16_f32 v220, 0, v220
    v_cvt_pk_bf16_f32 v221, 0, v221
    v_cvt_pk_bf16_f32 v222, 0, v222
    v_cvt_pk_bf16_f32 v223, 0, v223
    v_pk_fma_f32 v[208:209], v[208:209], v[64:65], v[66:67]
    v_pk_fma_f32 v[210:211], v[210:211], v[64:65], v[66:67]
    v_pk_fma_f32 v[212:213], v[212:213], v[64:65], v[66:67]
    v_pk_fma_f32 v[214:215], v[214:215], v[64:65], v[66:67]
    v_pk_fma_f32 v[216:217], v[216:217], v[64:65], v[66:67]
    v_pk_fma_f32 v[218:219], v[218:219], v[64:65], v[66:67]
    v_pk_fma_f32 v[220:221], v[220:221], v[64:65], v[66:67]
    v_pk_fma_f32 v[222:223], v[222:223], v[64:65], v[66:67]
    v_exp_f32 v208, v208
    v_exp_f32 v209, v209
    v_exp_f32 v210, v210
    v_exp_f32 v211, v211
    v_exp_f32 v212, v212
    v_exp_f32 v213, v213
    v_exp_f32 v214, v214
    v_exp_f32 v215, v215
    v_exp_f32 v216, v216
    v_exp_f32 v217, v217
    v_exp_f32 v218, v218
    v_exp_f32 v219, v219
    v_exp_f32 v220, v220
    v_exp_f32 v221, v221
    v_exp_f32 v222, v222
    v_exp_f32 v223, v223
    v_cvt_pk_bf16_f32 v208, v208, v209
    v_cvt_pk_bf16_f32 v209, v210, v211
    v_cvt_pk_bf16_f32 v210, v212, v213
    v_cvt_pk_bf16_f32 v211, v214, v215
    v_cvt_pk_bf16_f32 v212, v216, v217
    v_cvt_pk_bf16_f32 v213, v218, v219
    v_cvt_pk_bf16_f32 v214, v220, v221
    v_cvt_pk_bf16_f32 v215, v222, v223
    s_waitcnt lgkmcnt(4)
    v_mfma_f32_32x32x16_bf16 v[24:39], v[80:83], v[208:211], v[24:39]
    v_mfma_f32_32x32x16_bf16 v[24:39], v[84:87], v[212:215], v[24:39]
    s_waitcnt lgkmcnt(0)
    v_mfma_f32_32x32x16_bf16 v[24:39], v[88:91], v[224:227], v[24:39]
    v_mfma_f32_32x32x16_bf16 v[24:39], v[92:95], v[228:231], v[24:39]
    v_and_b32 v13, 31, v1
    s_mul_i32 s37, s22, 7
    v_add_u32 v2, s37, v14
    v_lshlrev_b32 v3, 4, v13
    s_lshl_b32 s36, s20, 6
    s_lshl_b32 s37, s21, 3
    s_add_u32 s36, s36, s37
    s_add_u32 s36, s36, s23
    s_mul_i32 s36, s36, 28672
    s_add_u32 s36, s36, 11014144
    v_lshrrev_b32 v4, 1, v2
    v_and_b32 v5, 1, v2
    v_lshl_add_u32 v4, v4, 9, v3
    v_lshl_add_u32 v4, v5, 3, v4
    v_mov_b32 v68, v36
    v_mov_b32 v69, v36
    s_nop 1
    v_permlane32_swap_b32 v68, v69
    v_rcp_f32 v69, v69
    s_nop 0
    v_mul_f32 v24, v24, v69
    v_mul_f32 v25, v25, v69
    v_mul_f32 v26, v26, v69
    v_mul_f32 v27, v27, v69
    v_mul_f32 v28, v28, v69
    v_mul_f32 v29, v29, v69
    v_mul_f32 v30, v30, v69
    v_mul_f32 v31, v31, v69
    v_mul_f32 v32, v32, v69
    v_mul_f32 v33, v33, v69
    v_mul_f32 v34, v34, v69
    v_mul_f32 v35, v35, v69
    v_mul_f32 v36, v36, v69
    v_mul_f32 v37, v37, v69
    v_mul_f32 v38, v38, v69
    v_mul_f32 v39, v39, v69
    v_cvt_pk_bf16_f32 v24, v24, v25
    v_cvt_pk_bf16_f32 v25, v26, v27
    v_cvt_pk_bf16_f32 v26, v28, v29
    v_cvt_pk_bf16_f32 v27, v30, v31
    v_cvt_pk_bf16_f32 v28, v32, v33
    v_cvt_pk_bf16_f32 v29, v34, v35
    v_cvt_pk_bf16_f32 v30, v36, v37
    v_cvt_pk_bf16_f32 v31, v38, v39
    buffer_store_dwordx2 v[24:25], v4, s[32:35], s36 offen offset:0
    buffer_store_dwordx2 v[26:27], v4, s[32:35], s36 offen offset:512
    buffer_store_dwordx2 v[28:29], v4, s[32:35], s36 offen offset:1024
    s_mov_b32 exec_hi, 0
    buffer_store_dwordx2 v[30:31], v4, s[32:35], s36 offen offset:1536
    s_mov_b64 exec, -1
K2_END:
    s_endpgm
.p2align 6
PH3:
    s_cmp_ge_u32 s2, 224
    s_cbranch_scc1 K3_END
    s_load_dwordx2 s[4:5], s[0:1], 16
    s_load_dwordx2 s[6:7], s[0:1], 40
    s_load_dwordx2 s[8:9], s[0:1], 48
    s_load_dwordx2 s[10:11], s[0:1], 64
    s_and_b32 s36, s2, 7
    s_lshr_b32 s37, s2, 3
    s_and_b32 s20, s36, 1
    s_lshr_b32 s38, s36, 1
    s_lshl_b32 s38, s38, 2
    s_and_b32 s39, s37, 3
    s_add_u32 s21, s38, s39
    s_lshr_b32 s22, s37, 2
    v_lshrrev_b32 v2, 6, v0
    v_and_b32 v1, 63, v0
    v_lshrrev_b32 v8, 3, v1
    v_readfirstlane_b32 s23, v2
    s_cmp_lt_u32 s23, 4
    s_cbranch_scc1 K3_COMPUTE
    s_sub_u32 s76, s23, 4
    v_and_b32 v9, 7, v1
    v_lshrrev_b32 v10, 4, v1
    v_and_b32 v10, 1, v10
    v_lshlrev_b32 v10, 2, v10
    v_xor_b32 v9, v9, v10
    v_mul_u32_u24 v8, 896, v8
    v_lshlrev_b32 v9, 4, v9
    v_add_u32 v2, v8, v9
    s_mul_i32 s36, s76, 14336
    s_lshl_b32 s37, s22, 7
    s_add_u32 s36, s36, s37
    s_lshl_b32 s37, s76, 11
    s_waitcnt lgkmcnt(0)
    s_cmp_eq_u32 s20, 0
    s_cselect_b32 s24, s4, s6
    s_cselect_b32 s25, s5, s7
    s_and_b32 s25, s25, 0xffff
    s_mov_b32 s26, 401408
    s_mov_b32 s27, 0x20000
    s_add_u32 s38, s36, 0
    s_add_u32 m0, s37, 0
    s_nop 0
    buffer_load_dwordx4 v2, s[24:27], s38 offen lds
    s_add_u32 s38, s36, 7168
    s_add_u32 m0, s37, 1024
    s_nop 0
    buffer_load_dwordx4 v2, s[24:27], s38 offen lds
    s_add_u32 s38, s36, 57344
    s_add_u32 m0, s37, 8192
    s_nop 0
    buffer_load_dwordx4 v2, s[24:27], s38 offen lds
    s_add_u32 s38, s36, 64512
    s_add_u32 m0, s37, 9216
    s_nop 0
    buffer_load_dwordx4 v2, s[24:27], s38 offen lds
    s_add_u32 s38, s36, 114688
    s_add_u32 m0, s37, 16384
    s_nop 0
    buffer_load_dwordx4 v2, s[24:27], s38 offen lds
    s_add_u32 s38, s36, 121856
    s_add_u32 m0, s37, 17408
    s_nop 0
    buffer_load_dwordx4 v2, s[24:27], s38 offen lds
    s_add_u32 s38, s36, 172032
    s_add_u32 m0, s37, 24576
    s_nop 0
    buffer_load_dwordx4 v2, s[24:27], s38 offen lds
    s_add_u32 s38, s36, 179200
    s_add_u32 m0, s37, 25600
    s_nop 0
    buffer_load_dwordx4 v2, s[24:27], s38 offen lds
    s_add_u32 s38, s36, 229376
    s_add_u32 m0, s37, 32768
    s_nop 0
    buffer_load_dwordx4 v2, s[24:27], s38 offen lds
    s_add_u32 s38, s36, 236544
    s_add_u32 m0, s37, 33792
    s_nop 0
    buffer_load_dwordx4 v2, s[24:27], s38 offen lds
    s_add_u32 s38, s36, 286720
    s_add_u32 m0, s37, 40960
    s_nop 0
    buffer_load_dwordx4 v2, s[24:27], s38 offen lds
    s_add_u32 s38, s36, 293888
    s_add_u32 m0, s37, 41984
    s_nop 0
    buffer_load_dwordx4 v2, s[24:27], s38 offen lds
    s_add_u32 s38, s36, 344064
    s_add_u32 m0, s37, 49152
    s_nop 0
    buffer_load_dwordx4 v2, s[24:27], s38 offen lds
    s_add_u32 s38, s36, 351232
    s_add_u32 m0, s37, 50176
    s_nop 0
    buffer_load_dwordx4 v2, s[24:27], s38 offen lds
    s_waitcnt vmcnt(12)
    s_barrier
    s_waitcnt vmcnt(10)
    s_barrier
    s_waitcnt vmcnt(8)
    s_barrier
    s_waitcnt vmcnt(6)
    s_barrier
    s_waitcnt vmcnt(4)
    s_barrier
    s_waitcnt vmcnt(2)
    s_barrier
    s_waitcnt vmcnt(0)
    s_barrier
    s_endpgm
K3_COMPUTE:
    v_lshlrev_b32 v3, 4, v1
    s_lshl_b32 s39, s20, 6
    s_lshl_b32 s38, s21, 2
    s_add_u32 s39, s39, s38
    s_add_u32 s39, s39, s23
    s_mul_i32 s39, s39, 28672
    s_add_u32 s39, s39, 11014144
    s_waitcnt lgkmcnt(0)
    s_mov_b32 s32, s10
    s_and_b32 s33, s11, 0xffff
    s_mov_b32 s34, 14684160
    s_mov_b32 s35, 0x20000
    buffer_load_dwordx4 v[64:67], v3, s[32:35], s39 offen offset:0
    buffer_load_dwordx4 v[68:71], v3, s[32:35], s39 offen offset:1024
    buffer_load_dwordx4 v[72:75], v3, s[32:35], s39 offen offset:2048
    buffer_load_dwordx4 v[76:79], v3, s[32:35], s39 offen offset:3072
    s_add_u32 s39, s39, 4096
    buffer_load_dwordx4 v[80:83], v3, s[32:35], s39 offen offset:0
    buffer_load_dwordx4 v[84:87], v3, s[32:35], s39 offen offset:1024
    buffer_load_dwordx4 v[88:91], v3, s[32:35], s39 offen offset:2048
    buffer_load_dwordx4 v[92:95], v3, s[32:35], s39 offen offset:3072
    s_add_u32 s39, s39, 4096
    buffer_load_dwordx4 v[96:99], v3, s[32:35], s39 offen offset:0
    buffer_load_dwordx4 v[100:103], v3, s[32:35], s39 offen offset:1024
    buffer_load_dwordx4 v[104:107], v3, s[32:35], s39 offen offset:2048
    buffer_load_dwordx4 v[108:111], v3, s[32:35], s39 offen offset:3072
    s_add_u32 s39, s39, 4096
    s_mov_b32 s28, s8
    s_and_b32 s29, s9, 0xffff
    s_mov_b32 s30, 3670016
    s_mov_b32 s31, 0x20000
    v_lshrrev_b32 v10, 5, v1
    v_lshlrev_b32 v10, 3, v10
    v_and_b32 v11, 15, v1
    v_lshrrev_b32 v12, 2, v11
    v_add_u32 v10, v10, v12
    v_lshlrev_b32 v10, 7, v10
    v_lshrrev_b32 v12, 3, v11
    v_lshlrev_b32 v12, 2, v12
    v_lshrrev_b32 v13, 4, v1
    v_and_b32 v13, 1, v13
    v_lshlrev_b32 v13, 1, v13
    v_add_u32 v12, v12, v13
    v_and_b32 v13, 3, v11
    v_lshrrev_b32 v14, 1, v13
    v_add_u32 v12, v12, v14
    v_lshlrev_b32 v12, 4, v12
    v_and_b32 v13, 1, v13
    v_lshlrev_b32 v13, 3, v13
    v_add3_u32 v8, v10, v12, v13
    v_xor_b32 v9, 64, v8
    v_and_b32 v10, 31, v1
    v_lshrrev_b32 v11, 5, v1
    v_mul_u32_u24 v10, 1792, v10
    v_lshlrev_b32 v11, 4, v11
    v_add_u32 v10, v10, v11
    s_lshl_b32 s36, s21, 7
    s_lshl_b32 s37, s23, 5
    s_add_u32 s36, s36, s37
    s_mul_i32 s36, s36, 1792
    s_mul_i32 s37, s20, 896
    s_add_u32 s36, s36, s37
    s_lshl_b32 s37, s22, 7
    s_add_u32 s36, s36, s37
    s_barrier
    ds_read_b64_tr_b16 v[48:49], v8 offset:0
    ds_read_b64_tr_b16 v[50:51], v8 offset:512
    ds_read_b64_tr_b16 v[52:53], v9 offset:0
    ds_read_b64_tr_b16 v[54:55], v9 offset:512
    buffer_load_dwordx4 v[112:115], v3, s[32:35], s39 offen offset:0
    buffer_load_dwordx4 v[116:119], v3, s[32:35], s39 offen offset:1024
    buffer_load_dwordx4 v[120:123], v3, s[32:35], s39 offen offset:2048
    buffer_load_dwordx4 v[124:127], v3, s[32:35], s39 offen offset:3072
    s_add_u32 s39, s39, 4096
    s_waitcnt vmcnt(12)
    ds_read_b64_tr_b16 v[56:57], v8 offset:2048
    ds_read_b64_tr_b16 v[58:59], v8 offset:2560
    ds_read_b64_tr_b16 v[60:61], v9 offset:2048
    ds_read_b64_tr_b16 v[62:63], v9 offset:2560
    s_waitcnt lgkmcnt(4)
    v_mfma_f32_32x32x16_bf16 v[16:31], v[48:51], v[64:67], 0
    v_mfma_f32_32x32x16_bf16 v[32:47], v[52:55], v[64:67], 0
    ds_read_b64_tr_b16 v[48:49], v8 offset:4096
    ds_read_b64_tr_b16 v[50:51], v8 offset:4608
    ds_read_b64_tr_b16 v[52:53], v9 offset:4096
    ds_read_b64_tr_b16 v[54:55], v9 offset:4608
    s_waitcnt lgkmcnt(4)
    v_mfma_f32_32x32x16_bf16 v[16:31], v[56:59], v[68:71], v[16:31]
    v_mfma_f32_32x32x16_bf16 v[32:47], v[60:63], v[68:71], v[32:47]
    ds_read_b64_tr_b16 v[56:57], v8 offset:6144
    ds_read_b64_tr_b16 v[58:59], v8 offset:6656
    ds_read_b64_tr_b16 v[60:61], v9 offset:6144
    ds_read_b64_tr_b16 v[62:63], v9 offset:6656
    s_waitcnt lgkmcnt(4)
    v_mfma_f32_32x32x16_bf16 v[16:31], v[48:51], v[72:75], v[16:31]
    v_mfma_f32_32x32x16_bf16 v[32:47], v[52:55], v[72:75], v[32:47]
    s_waitcnt lgkmcnt(0)
    v_mfma_f32_32x32x16_bf16 v[16:31], v[56:59], v[76:79], v[16:31]
    v_mfma_f32_32x32x16_bf16 v[32:47], v[60:63], v[76:79], v[32:47]
    s_barrier
    ds_read_b64_tr_b16 v[48:49], v8 offset:8192
    ds_read_b64_tr_b16 v[50:51], v8 offset:8704
    ds_read_b64_tr_b16 v[52:53], v9 offset:8192
    ds_read_b64_tr_b16 v[54:55], v9 offset:8704
    buffer_load_dwordx4 v[128:131], v3, s[32:35], s39 offen offset:0
    buffer_load_dwordx4 v[132:135], v3, s[32:35], s39 offen offset:1024
    buffer_load_dwordx4 v[136:139], v3, s[32:35], s39 offen offset:2048
    buffer_load_dwordx4 v[140:143], v3, s[32:35], s39 offen offset:3072
    s_add_u32 s39, s39, 4096
    s_waitcnt vmcnt(12)
    ds_read_b64_tr_b16 v[56:57], v8 offset:10240
    ds_read_b64_tr_b16 v[58:59], v8 offset:10752
    ds_read_b64_tr_b16 v[60:61], v9 offset:10240
    ds_read_b64_tr_b16 v[62:63], v9 offset:10752
    s_waitcnt lgkmcnt(4)
    v_mfma_f32_32x32x16_bf16 v[16:31], v[48:51], v[80:83], v[16:31]
    v_mfma_f32_32x32x16_bf16 v[32:47], v[52:55], v[80:83], v[32:47]
    ds_read_b64_tr_b16 v[48:49], v8 offset:12288
    ds_read_b64_tr_b16 v[50:51], v8 offset:12800
    ds_read_b64_tr_b16 v[52:53], v9 offset:12288
    ds_read_b64_tr_b16 v[54:55], v9 offset:12800
    s_waitcnt lgkmcnt(4)
    v_mfma_f32_32x32x16_bf16 v[16:31], v[56:59], v[84:87], v[16:31]
    v_mfma_f32_32x32x16_bf16 v[32:47], v[60:63], v[84:87], v[32:47]
    ds_read_b64_tr_b16 v[56:57], v8 offset:14336
    ds_read_b64_tr_b16 v[58:59], v8 offset:14848
    ds_read_b64_tr_b16 v[60:61], v9 offset:14336
    ds_read_b64_tr_b16 v[62:63], v9 offset:14848
    s_waitcnt lgkmcnt(4)
    v_mfma_f32_32x32x16_bf16 v[16:31], v[48:51], v[88:91], v[16:31]
    v_mfma_f32_32x32x16_bf16 v[32:47], v[52:55], v[88:91], v[32:47]
    s_waitcnt lgkmcnt(0)
    v_mfma_f32_32x32x16_bf16 v[16:31], v[56:59], v[92:95], v[16:31]
    v_mfma_f32_32x32x16_bf16 v[32:47], v[60:63], v[92:95], v[32:47]
    s_barrier
    ds_read_b64_tr_b16 v[48:49], v8 offset:16384
    ds_read_b64_tr_b16 v[50:51], v8 offset:16896
    ds_read_b64_tr_b16 v[52:53], v9 offset:16384
    ds_read_b64_tr_b16 v[54:55], v9 offset:16896
    buffer_load_dwordx4 v[144:147], v3, s[32:35], s39 offen offset:0
    buffer_load_dwordx4 v[148:151], v3, s[32:35], s39 offen offset:1024
    buffer_load_dwordx4 v[152:155], v3, s[32:35], s39 offen offset:2048
    buffer_load_dwordx4 v[156:159], v3, s[32:35], s39 offen offset:3072
    s_add_u32 s39, s39, 4096
    s_waitcnt vmcnt(12)
    ds_read_b64_tr_b16 v[56:57], v8 offset:18432
    ds_read_b64_tr_b16 v[58:59], v8 offset:18944
    ds_read_b64_tr_b16 v[60:61], v9 offset:18432
    ds_read_b64_tr_b16 v[62:63], v9 offset:18944
    s_waitcnt lgkmcnt(4)
    v_mfma_f32_32x32x16_bf16 v[16:31], v[48:51], v[96:99], v[16:31]
    v_mfma_f32_32x32x16_bf16 v[32:47], v[52:55], v[96:99], v[32:47]
    ds_read_b64_tr_b16 v[48:49], v8 offset:20480
    ds_read_b64_tr_b16 v[50:51], v8 offset:20992
    ds_read_b64_tr_b16 v[52:53], v9 offset:20480
    ds_read_b64_tr_b16 v[54:55], v9 offset:20992
    s_waitcnt lgkmcnt(4)
    v_mfma_f32_32x32x16_bf16 v[16:31], v[56:59], v[100:103], v[16:31]
    v_mfma_f32_32x32x16_bf16 v[32:47], v[60:63], v[100:103], v[32:47]
    ds_read_b64_tr_b16 v[56:57], v8 offset:22528
    ds_read_b64_tr_b16 v[58:59], v8 offset:23040
    ds_read_b64_tr_b16 v[60:61], v9 offset:22528
    ds_read_b64_tr_b16 v[62:63], v9 offset:23040
    s_waitcnt lgkmcnt(4)
    v_mfma_f32_32x32x16_bf16 v[16:31], v[48:51], v[104:107], v[16:31]
    v_mfma_f32_32x32x16_bf16 v[32:47], v[52:55], v[104:107], v[32:47]
    s_waitcnt lgkmcnt(0)
    v_mfma_f32_32x32x16_bf16 v[16:31], v[56:59], v[108:111], v[16:31]
    v_mfma_f32_32x32x16_bf16 v[32:47], v[60:63], v[108:111], v[32:47]
    s_barrier
    ds_read_b64_tr_b16 v[48:49], v8 offset:24576
    ds_read_b64_tr_b16 v[50:51], v8 offset:25088
    ds_read_b64_tr_b16 v[52:53], v9 offset:24576
    ds_read_b64_tr_b16 v[54:55], v9 offset:25088
    buffer_load_dwordx4 v[160:163], v3, s[32:35], s39 offen offset:0
    buffer_load_dwordx4 v[164:167], v3, s[32:35], s39 offen offset:1024
    buffer_load_dwordx4 v[168:171], v3, s[32:35], s39 offen offset:2048
    buffer_load_dwordx4 v[172:175], v3, s[32:35], s39 offen offset:3072
    s_add_u32 s39, s39, 4096
    s_waitcnt vmcnt(12)
    ds_read_b64_tr_b16 v[56:57], v8 offset:26624
    ds_read_b64_tr_b16 v[58:59], v8 offset:27136
    ds_read_b64_tr_b16 v[60:61], v9 offset:26624
    ds_read_b64_tr_b16 v[62:63], v9 offset:27136
    s_waitcnt lgkmcnt(4)
    v_mfma_f32_32x32x16_bf16 v[16:31], v[48:51], v[112:115], v[16:31]
    v_mfma_f32_32x32x16_bf16 v[32:47], v[52:55], v[112:115], v[32:47]
    ds_read_b64_tr_b16 v[48:49], v8 offset:28672
    ds_read_b64_tr_b16 v[50:51], v8 offset:29184
    ds_read_b64_tr_b16 v[52:53], v9 offset:28672
    ds_read_b64_tr_b16 v[54:55], v9 offset:29184
    s_waitcnt lgkmcnt(4)
    v_mfma_f32_32x32x16_bf16 v[16:31], v[56:59], v[116:119], v[16:31]
    v_mfma_f32_32x32x16_bf16 v[32:47], v[60:63], v[116:119], v[32:47]
    ds_read_b64_tr_b16 v[56:57], v8 offset:30720
    ds_read_b64_tr_b16 v[58:59], v8 offset:31232
    ds_read_b64_tr_b16 v[60:61], v9 offset:30720
    ds_read_b64_tr_b16 v[62:63], v9 offset:31232
    s_waitcnt lgkmcnt(4)
    v_mfma_f32_32x32x16_bf16 v[16:31], v[48:51], v[120:123], v[16:31]
    v_mfma_f32_32x32x16_bf16 v[32:47], v[52:55], v[120:123], v[32:47]
    s_waitcnt lgkmcnt(0)
    v_mfma_f32_32x32x16_bf16 v[16:31], v[56:59], v[124:127], v[16:31]
    v_mfma_f32_32x32x16_bf16 v[32:47], v[60:63], v[124:127], v[32:47]
    s_barrier
    ds_read_b64_tr_b16 v[48:49], v8 offset:32768
    ds_read_b64_tr_b16 v[50:51], v8 offset:33280
    ds_read_b64_tr_b16 v[52:53], v9 offset:32768
    ds_read_b64_tr_b16 v[54:55], v9 offset:33280
    s_waitcnt vmcnt(8)
    ds_read_b64_tr_b16 v[56:57], v8 offset:34816
    ds_read_b64_tr_b16 v[58:59], v8 offset:35328
    ds_read_b64_tr_b16 v[60:61], v9 offset:34816
    ds_read_b64_tr_b16 v[62:63], v9 offset:35328
    s_waitcnt lgkmcnt(4)
    v_mfma_f32_32x32x16_bf16 v[16:31], v[48:51], v[128:131], v[16:31]
    v_mfma_f32_32x32x16_bf16 v[32:47], v[52:55], v[128:131], v[32:47]
    ds_read_b64_tr_b16 v[48:49], v8 offset:36864
    ds_read_b64_tr_b16 v[50:51], v8 offset:37376
    ds_read_b64_tr_b16 v[52:53], v9 offset:36864
    ds_read_b64_tr_b16 v[54:55], v9 offset:37376
    s_waitcnt lgkmcnt(4)
    v_mfma_f32_32x32x16_bf16 v[16:31], v[56:59], v[132:135], v[16:31]
    v_mfma_f32_32x32x16_bf16 v[32:47], v[60:63], v[132:135], v[32:47]
    ds_read_b64_tr_b16 v[56:57], v8 offset:38912
    ds_read_b64_tr_b16 v[58:59], v8 offset:39424
    ds_read_b64_tr_b16 v[60:61], v9 offset:38912
    ds_read_b64_tr_b16 v[62:63], v9 offset:39424
    s_waitcnt lgkmcnt(4)
    v_mfma_f32_32x32x16_bf16 v[16:31], v[48:51], v[136:139], v[16:31]
    v_mfma_f32_32x32x16_bf16 v[32:47], v[52:55], v[136:139], v[32:47]
    s_waitcnt lgkmcnt(0)
    v_mfma_f32_32x32x16_bf16 v[16:31], v[56:59], v[140:143], v[16:31]
    v_mfma_f32_32x32x16_bf16 v[32:47], v[60:63], v[140:143], v[32:47]
    s_barrier
    ds_read_b64_tr_b16 v[48:49], v8 offset:40960
    ds_read_b64_tr_b16 v[50:51], v8 offset:41472
    ds_read_b64_tr_b16 v[52:53], v9 offset:40960
    ds_read_b64_tr_b16 v[54:55], v9 offset:41472
    s_waitcnt vmcnt(4)
    ds_read_b64_tr_b16 v[56:57], v8 offset:43008
    ds_read_b64_tr_b16 v[58:59], v8 offset:43520
    ds_read_b64_tr_b16 v[60:61], v9 offset:43008
    ds_read_b64_tr_b16 v[62:63], v9 offset:43520
    s_waitcnt lgkmcnt(4)
    v_mfma_f32_32x32x16_bf16 v[16:31], v[48:51], v[144:147], v[16:31]
    v_mfma_f32_32x32x16_bf16 v[32:47], v[52:55], v[144:147], v[32:47]
    ds_read_b64_tr_b16 v[48:49], v8 offset:45056
    ds_read_b64_tr_b16 v[50:51], v8 offset:45568
    ds_read_b64_tr_b16 v[52:53], v9 offset:45056
    ds_read_b64_tr_b16 v[54:55], v9 offset:45568
    s_waitcnt lgkmcnt(4)
    v_mfma_f32_32x32x16_bf16 v[16:31], v[56:59], v[148:151], v[16:31]
    v_mfma_f32_32x32x16_bf16 v[32:47], v[60:63], v[148:151], v[32:47]
    ds_read_b64_tr_b16 v[56:57], v8 offset:47104
    ds_read_b64_tr_b16 v[58:59], v8 offset:47616
    ds_read_b64_tr_b16 v[60:61], v9 offset:47104
    ds_read_b64_tr_b16 v[62:63], v9 offset:47616
    s_waitcnt lgkmcnt(4)
    v_mfma_f32_32x32x16_bf16 v[16:31], v[48:51], v[152:155], v[16:31]
    v_mfma_f32_32x32x16_bf16 v[32:47], v[52:55], v[152:155], v[32:47]
    s_waitcnt lgkmcnt(0)
    v_mfma_f32_32x32x16_bf16 v[16:31], v[56:59], v[156:159], v[16:31]
    v_mfma_f32_32x32x16_bf16 v[32:47], v[60:63], v[156:159], v[32:47]
    s_barrier
    ds_read_b64_tr_b16 v[48:49], v8 offset:49152
    ds_read_b64_tr_b16 v[50:51], v8 offset:49664
    ds_read_b64_tr_b16 v[52:53], v9 offset:49152
    ds_read_b64_tr_b16 v[54:55], v9 offset:49664
    s_waitcnt vmcnt(0)
    ds_read_b64_tr_b16 v[56:57], v8 offset:51200
    ds_read_b64_tr_b16 v[58:59], v8 offset:51712
    ds_read_b64_tr_b16 v[60:61], v9 offset:51200
    ds_read_b64_tr_b16 v[62:63], v9 offset:51712
    s_waitcnt lgkmcnt(4)
    v_mfma_f32_32x32x16_bf16 v[16:31], v[48:51], v[160:163], v[16:31]
    v_mfma_f32_32x32x16_bf16 v[32:47], v[52:55], v[160:163], v[32:47]
    ds_read_b64_tr_b16 v[48:49], v8 offset:53248
    ds_read_b64_tr_b16 v[50:51], v8 offset:53760
    ds_read_b64_tr_b16 v[52:53], v9 offset:53248
    ds_read_b64_tr_b16 v[54:55], v9 offset:53760
    s_waitcnt lgkmcnt(4)
    v_mfma_f32_32x32x16_bf16 v[16:31], v[56:59], v[164:167], v[16:31]
    v_mfma_f32_32x32x16_bf16 v[32:47], v[60:63], v[164:167], v[32:47]
    ds_read_b64_tr_b16 v[56:57], v8 offset:55296
    ds_read_b64_tr_b16 v[58:59], v8 offset:55808
    ds_read_b64_tr_b16 v[60:61], v9 offset:55296
    ds_read_b64_tr_b16 v[62:63], v9 offset:55808
    s_waitcnt lgkmcnt(4)
    v_mfma_f32_32x32x16_bf16 v[16:31], v[48:51], v[168:171], v[16:31]
    v_mfma_f32_32x32x16_bf16 v[32:47], v[52:55], v[168:171], v[32:47]
    s_waitcnt lgkmcnt(0)
    v_mfma_f32_32x32x16_bf16 v[16:31], v[56:59], v[172:175], v[16:31]
    v_mfma_f32_32x32x16_bf16 v[32:47], v[60:63], v[172:175], v[32:47]
    s_nop 10
    v_cvt_pk_bf16_f32 v16, v16, v17
    v_cvt_pk_bf16_f32 v17, v18, v19
    v_cvt_pk_bf16_f32 v18, v20, v21
    v_cvt_pk_bf16_f32 v19, v22, v23
    v_cvt_pk_bf16_f32 v20, v24, v25
    v_cvt_pk_bf16_f32 v21, v26, v27
    v_cvt_pk_bf16_f32 v22, v28, v29
    v_cvt_pk_bf16_f32 v23, v30, v31
    v_permlane32_swap_b32 v16, v18
    v_permlane32_swap_b32 v17, v19
    buffer_store_dwordx4 v[16:19], v10, s[28:31], s36 offen offset:0
    v_permlane32_swap_b32 v20, v22
    v_permlane32_swap_b32 v21, v23
    buffer_store_dwordx4 v[20:23], v10, s[28:31], s36 offen offset:32
    v_cvt_pk_bf16_f32 v32, v32, v33
    v_cvt_pk_bf16_f32 v33, v34, v35
    v_cvt_pk_bf16_f32 v34, v36, v37
    v_cvt_pk_bf16_f32 v35, v38, v39
    v_cvt_pk_bf16_f32 v36, v40, v41
    v_cvt_pk_bf16_f32 v37, v42, v43
    v_cvt_pk_bf16_f32 v38, v44, v45
    v_cvt_pk_bf16_f32 v39, v46, v47
    v_permlane32_swap_b32 v32, v34
    v_permlane32_swap_b32 v33, v35
    buffer_store_dwordx4 v[32:35], v10, s[28:31], s36 offen offset:64
    v_permlane32_swap_b32 v36, v38
    v_permlane32_swap_b32 v37, v39
    buffer_store_dwordx4 v[36:39], v10, s[28:31], s36 offen offset:96
K3_END:
    s_endpgm
CODE_END:
.section .rodata,"a"
.p2align 6
.amdhsa_kernel fused_kernel
  .amdhsa_next_free_vgpr 240
  .amdhsa_next_free_sgpr 102
  .amdhsa_accum_offset 240
  .amdhsa_group_segment_fixed_size 0
  .amdhsa_kernarg_size 72
  .amdhsa_user_sgpr_count 2
  .amdhsa_user_sgpr_kernarg_segment_ptr 1
  .amdhsa_system_sgpr_workgroup_id_x 1
.end_amdhsa_kernel
```
